```python
import torch

def _softmax(x, axis=-1):
    return torch.softmax(x, dim=axis)
def _gelu(x):
    return torch.nn.functional.gelu(x, approximate="tanh")
def _silu(x):
    return torch.nn.functional.silu(x)
def _sigmoid(x):
    return torch.sigmoid(x)
def _layernorm(x, axis=-1, eps=1e-5):
    m = x.mean(dim=axis, keepdim=True)
    v = x.var(dim=axis, keepdim=True, unbiased=False)
    return (x - m) / torch.sqrt(v + eps)
def _scatter_add(tgt, idx, src, axis=0):
    return tgt.clone().index_add_(axis, idx, src)
def _segment_sum(src, seg, n):
    out = torch.zeros((n,) + src.shape[1:], dtype=src.dtype)
    return out.index_add_(0, seg, src)
def _pad(x, pw):
    flat = tuple(v for pair in reversed(pw) for v in pair)
    return torch.nn.functional.pad(x, flat)

kernel_name = 'gated_mix__ssm_conv_s5__dense_activation_mish__prompt'

def setup_inputs():

    _w = (lambda a: (lambda t: t.to(torch.bfloat16) if t.is_floating_point() else t)(torch.as_tensor(a)))
    def _A_setup():
        B, S, D = 1, 2048, 448
        P = D
        Lambda_re = -0.5 * (lambda _x: torch.exp(torch.as_tensor(_x)))((lambda *s: torch.randn(*s, dtype=torch.bfloat16) * 0.1)(P))
        Lambda_im = (lambda *s: torch.randn(*s, dtype=torch.bfloat16) * 0.2)(P) * 1.0
        B_re = (lambda *s: torch.randn(*s, dtype=torch.bfloat16) * 0.2)(P, D) * (D ** -0.5)
        B_im = (lambda *s: torch.randn(*s, dtype=torch.bfloat16) * 0.2)(P, D) * (D ** -0.5)
        C_re = (lambda *s: torch.randn(*s, dtype=torch.bfloat16) * 0.2)(D, P) * (P ** -0.5)
        C_im = (lambda *s: torch.randn(*s, dtype=torch.bfloat16) * 0.2)(D, P) * (P ** -0.5)
        log_dt = (lambda *s: torch.randn(*s, dtype=torch.bfloat16) * 0.1)(P) * 0.3 - 2.0
        Dskip = (lambda *s: torch.randn(*s, dtype=torch.bfloat16) * 0.05)(D)
        return {
            "x": _w((lambda *s: torch.randn(*s, dtype=torch.bfloat16) * 0.05)(B, S, D)),
            "Lambda_re": _w(Lambda_re),
            "Lambda_im": _w(Lambda_im),
            "B_re": _w(B_re),
            "B_im": _w(B_im),
            "C_re": _w(C_re),
            "C_im": _w(C_im),
            "log_dt": _w(log_dt),
            "Dskip": _w(Dskip),
        }
    _A_in = _A_setup()

    def _B_setup():
        B, S, D, F = 1, 2048, 448, 1792
        return {
            "x": _w((lambda *s: torch.randn(*s, dtype=torch.bfloat16) * 0.05)(B, S, D)),
            "w1": _w((lambda *s: torch.randn(*s, dtype=torch.bfloat16) * 3.2)(D, F) * (D ** -0.5)),
            "b1": _w((lambda *s: torch.randn(*s, dtype=torch.bfloat16) * 0.05)(F)),
            "w2": _w((lambda *s: torch.randn(*s, dtype=torch.bfloat16) * 0.05)(F, D) * (F ** -0.5)),
        }
    _B_in = _B_setup()

    return {
        "A_x": _A_in["x"],
        "A_Lambda_re": _A_in["Lambda_re"],
        "A_Lambda_im": _A_in["Lambda_im"],
        "A_B_re": _A_in["B_re"],
        "A_B_im": _A_in["B_im"],
        "A_C_re": _A_in["C_re"],
        "A_C_im": _A_in["C_im"],
        "A_log_dt": _A_in["log_dt"],
        "A_Dskip": _A_in["Dskip"],
        "B_x": _B_in["x"],
        "B_w1": _B_in["w1"],
        "B_b1": _B_in["b1"],
        "B_w2": _B_in["w2"],
        "gate_w": _w((lambda *s: torch.randn(*s, dtype=torch.bfloat16) * 0.05)(448) * 16.0),
    }

def reference(A_x, A_Lambda_re, A_Lambda_im, A_B_re, A_B_im, A_C_re, A_C_im, A_log_dt, A_Dskip, B_x, B_w1, B_b1, B_w2, gate_w):
    def _A_ref(x, Lambda_re, Lambda_im, B_re, B_im, C_re, C_im, log_dt, Dskip):
        Bsz, L, H = x.shape
        Lam = Lambda_re + 1j * Lambda_im
        Bmat = B_re + 1j * B_im
        Cmat = C_re + 1j * C_im
        dt = torch.exp(log_dt)
        Lam_bar = torch.exp(dt * Lam)
        B_bar = ((Lam_bar - 1.0) / Lam)[:, None] * Bmat
        Bu = torch.einsum("bld,pd->blp", x + 0j, B_bar)
        h = torch.zeros_like(Bu[:, 0, :])
        hs = []
        for t in range(L):
            h = Lam_bar[None, :] * h + Bu[:, t, :]
            hs.append(h)
        hseq = torch.stack(hs, 1)
        y = 2.0 * torch.einsum("blp,dp->bld", hseq, Cmat).real + x * Dskip[None, None, :]
        return y

    def _B_ref(x, w1, b1, w2):
        h = torch.einsum("bsd,df->bsf", x, w1) + b1
        sp = torch.log1p(torch.exp(-torch.abs(h))) + torch.where(h > 0, h, torch.zeros_like(h))
        act = h * torch.tanh(sp)
        return torch.einsum("bsf,fd->bsd", act, w2)

    x = A_x
    g = _sigmoid((x * gate_w).sum(-1, keepdims=True))
    a = _A_ref(x, A_Lambda_re, A_Lambda_im, A_B_re, A_B_im, A_C_re, A_C_im, A_log_dt, A_Dskip)
    b = _B_ref(x, B_w1, B_b1, B_w2)
    return g * a + (1 - g) * b
```

```asm
; @launch grid=(256,1,1) block=(256,1,1) lds=163840
.amdgcn_target "amdgcn-amd-amdhsa--gfx950"
.text
.globl gated_mix__ssm_conv_s5__dense_activation_mish__prompt_kernel
.p2align 12
.p2align 8
.type gated_mix__ssm_conv_s5__dense_activation_mish__prompt_kernel,@function
gated_mix__ssm_conv_s5__dense_activation_mish__prompt_kernel:
    s_load_dwordx16 s[4:19], s[0:1], 0
    s_load_dwordx16 s[36:51], s[0:1], 64
    s_load_dwordx2 s[52:53], s[0:1], 128
    v_lshrrev_b32 v1, 6, v0
    s_cmp_ge_u32 s2, 256
    s_cbranch_scc1 L_end
    v_readfirstlane_b32 s64, v1
    s_and_b32 s69, s2, 7
    s_lshr_b32 s70, s2, 3
    s_mov_b32 s26, 0x62000
    s_mov_b32 s27, 0x20000
    s_cmp_lt_u32 s70, 4
    s_cbranch_scc1 L_helper
    v_and_b32 v0, 63, v0
    s_lshl_b32 s68, s69, 2
    s_lshr_b32 s68, 0xaa99bbbb, s68
    s_and_b32 s68, s68, 15
    s_lshl_b32 s68, s68, 1
    s_mov_b32 s72, 0x4afc6a1c
    s_mov_b32 s73, 0x9cac3c0e
    s_lshl_b32 s69, s69, 3
    s_cmp_lt_u32 s70, s68
    s_cselect_b32 s72, s72, 0xc06ab674
    s_cselect_b32 s73, s73, 0xac804e20
    s_lshr_b64 s[72:73], s[72:73], s69
    s_add_u32 s70, s70, s72
    s_and_b32 s62, s70, 31
    s_bfe_u32 s63, s70, 0x30005
    s_and_b32 s65, s64, 1
    s_lshr_b32 s66, s64, 1
    s_mul_i32 s69, s63, 4
    s_lshl1_add_u32 s69, s62, s69
    s_mul_i32 s70, s69, 37
    s_lshr_b32 s70, s70, 8
    s_mul_i32 s70, s70, 7
    s_sub_u32 s69, s69, s70
    s_lshl_b32 s82, s69, 7
    s_mov_b32 s22, 0x1c0000
    s_mov_b32 s23, 0x20000
    s_mov_b32 s34, 0x380
    s_mov_b32 s35, 0x20000
    s_mov_b32 s30, 0x65800
    s_mov_b32 s31, 0x20000
    v_lshrrev_b32 v192, 4, v0
    v_and_b32 v200, 7, v0
    v_xor_b32 v200, v192, v200
    s_lshl1_add_u32 s69, s62, s66
    s_lshl2_add_u32 s69, s69, s65
    s_mul_i32 s69, s69, 7168
    v_lshl_add_u32 v202, v200, 4, s69
    v_lshrrev_b32 v193, 5, v0
    v_bfe_u32 v201, v0, 3, 2
    v_lshl_add_u32 v201, v193, 4, v201
    s_movk_i32 s69, 896
    v_mad_u32_u24 v204, v201, s69, v202
    v_xor_b32 v205, 64, v204
    v_add_u32 v205, 2560, v205
    s_lshl2_add_u32 s70, s63, s64
    s_mul_i32 s76, s70, 14336
    v_lshl_add_u32 v202, v200, 4, s76
    v_lshrrev_b32 v201, 3, v0
    v_mad_u32_u24 v1, v201, s69, v202
    v_xor_b32 v2, 64, v1
    v_add_u32 v3, 12288, v1
    v_add_u32 v4, 18432, v2
    v_add_u32 v2, 6144, v2
    s_lshl_b32 s68, s64, 8
    s_add_u32 m0, s68, 155648
    s_add_u32 s68, s68, s82
    v_lshl_add_u32 v202, v0, 2, s68
    v_subrev_u32 v201, s69, v202
    v_min_u32 v202, v201, v202
    s_mul_i32 s67, s64, 24576
    s_add_u32 s67, s67, 57344
    s_lshl_b32 s77, s64, 11
    s_waitcnt lgkmcnt(0)
    s_mov_b64 s[32:33], s[46:47]
    s_mov_b64 s[20:21], s[4:5]
    buffer_load_dword v202, s[32:35], 0 offen lds
    s_mov_b64 s[24:25], s[10:11]
    s_sub_u32 s28, s12, 14336
    s_subb_u32 s29, s13, 0
    s_add_u32 m0, s77, 0
    s_nop 0
    buffer_load_dwordx4 v204, s[20:23], s82 offen lds
    buffer_load_dwordx4 v205, s[20:23], s82 offen offset:1024 lds
    s_add_u32 m0, s67, 0
    s_nop 0
    buffer_load_dwordx4 v1, s[24:27], s82 offen lds
    buffer_load_dwordx4 v2, s[24:27], s82 offen offset:1024 lds
    buffer_load_dwordx4 v3, s[28:31], s82 offen offset:2048 lds
    buffer_load_dwordx4 v4, s[28:31], s82 offen offset:3072 lds
    v_and_b32 v194, 15, v0
    v_and_b32 v195, 31, v0
    s_lshl_b32 s69, s70, 5
    v_lshl_add_u32 v126, v194, 1, s69
    s_lshl_b32 s69, s70, 12
    s_lshl3_add_u32 s70, s63, s64
    s_lshl_b32 s70, s70, 6
    v_lshl_add_u32 v127, v195, 1, s70
    s_lshl1_add_u32 s80, s63, s65
    s_lshl_b32 s80, s80, 6
    v_lshl_add_u32 v47, v195, 1, s80
    global_load_ushort v122, v126, s[18:19]
    global_load_ushort v120, v126, s[6:7]
    global_load_ushort v121, v126, s[8:9]
    global_load_ushort v240, v127, s[42:43]
    global_load_ushort v244, v127, s[42:43] offset:256
    global_load_ushort v47, v47, s[36:37]
    s_add_u32 s36, s52, s69
    s_addc_u32 s37, s53, 0
    v_and_b32 v196, 3, v0
    v_lshrrev_b32 v200, 2, v0
    v_lshlrev_b32 v201, 4, v196
    s_movk_i32 s69, 896
    v_mul_u32_u24 v9, v200, s69
    v_add_u32 v9, v9, v201
    v_add_u32 v201, s70, v201
    s_movk_i32 s69, 3584
    v_mad_u32_u24 v5, v200, s69, v201
    v_add_u32 v6, 56320, v5
    v_add_u32 v7, 112640, v5
    v_add_u32 v8, 168960, v5
    s_mov_b32 s42, 0x188000
    s_mov_b32 s43, 0x20000
    v_bfe_u32 v203, v0, 1, 3
    v_xor_b32 v200, v203, v193
    v_lshlrev_b32 v200, 4, v200
    v_lshl_add_u32 v13, v195, 7, v200
    v_xor_b32 v14, 32, v13
    v_xor_b32 v15, 64, v13
    v_xor_b32 v16, 96, v13
    v_add_u32 v17, s67, v13
    v_add_u32 v18, s67, v14
    v_add_u32 v19, s67, v15
    v_add_u32 v20, s67, v16
    v_xor_b32 v200, v203, v192
    v_lshl_add_u32 v200, v200, 4, s77
    v_lshl_add_u32 v112, v194, 7, v200
    v_xor_b32 v113, 64, v112
    v_lshlrev_b32 v200, 4, v192
    v_add_u32 v114, 155648, v200
    s_add_u32 s83, s82, 128
    s_cmp_eq_u32 s83, 896
    s_cselect_b32 s83, 0, s83
    s_add_u32 m0, s77, 8192
    s_nop 0
    buffer_load_dwordx4 v204, s[20:23], s83 offen lds
    buffer_load_dwordx4 v205, s[20:23], s83 offen offset:1024 lds
    s_add_u32 m0, s67, 4096
    s_nop 0
    buffer_load_dwordx4 v1, s[24:27], s83 offen lds
    buffer_load_dwordx4 v2, s[24:27], s83 offen offset:1024 lds
    v_bfe_u32 v197, v0, 2, 2
    v_and_b32 v198, 1, v192
    v_lshl_add_u32 v200, v196, 3, s67
    v_lshl_add_u32 v200, v198, 5, v200
    v_lshl_add_u32 v200, v197, 6, v200
    v_lshl_add_u32 v21, v193, 9, v200
    v_lshl_add_u32 v22, v193, 8, v200
    v_add_u32 v10, 13312, v9
    v_add_u32 v11, 26624, v9
    v_add_u32 v12, 39936, v9
    s_lshl_b32 s69, s64, 6
    s_add_u32 s69, s69, 156672
    v_lshl_add_u32 v115, v194, 2, s69
    s_lshl_b32 s69, s63, 7
    s_sub_u32 s69, s69, s82
    s_cselect_b32 s70, 896, 0
    s_add_u32 s69, s69, s70
    s_lshl_b32 s69, s69, 6
    s_mul_i32 s70, s66, 4096
    s_add_u32 s69, s69, s70
    s_lshl_b32 s70, s65, 6
    s_add_u32 s69, s69, s70
    v_lshl_add_u32 v200, v193, 2, v197
    v_lshrrev_b32 v201, 1, v200
    v_bfe_u32 v202, v0, 1, 1
    v_lshl_add_u32 v202, v198, 1, v202
    v_xor_b32 v201, v201, v202
    v_lshl_add_u32 v201, v201, 4, s69
    v_lshl_add_u32 v201, v200, 7, v201
    v_and_b32 v203, 1, v0
    v_lshl_add_u32 v116, v203, 3, v201
    v_xor_b32 v117, 64, v116
    s_mov_b32 s69, 156672
    v_lshl_add_u32 v200, v193, 4, s69
    v_lshl_add_u32 v254, v198, 7, v200
    v_lshl_add_u32 v119, v195, 2, s69
    v_min_u32 v255, 27, v0
    v_lshlrev_b32 v255, 2, v255
    s_mov_b64 s[56:57], s[50:51]
    s_mov_b32 s58, 0x100
    s_mov_b32 s59, 0x20000
    s_mov_b32 s38, 0x1000
    s_mov_b32 s39, 0x20000
    s_mov_b32 s54, 0x10000000
    s_mov_b32 s55, 0x20000
    s_mov_b32 s72, 0x3fb8aa3b
    s_mov_b32 s73, 0x3fb8aa3b
    s_mov_b32 s74, 1.0
    s_mov_b32 s75, 1.0
    s_mov_b32 s71, 2097152
    s_lshl_b32 s69, s66, 11
    v_lshl_add_u32 v23, v0, 4, s69
    v_xor_b32 v24, 2048, v23
    v_or_b32 v25, v192, v0
    v_lshlrev_b32 v25, 28, v25
    s_sub_u32 s69, 32, s62
    s_lshl_b32 s69, s69, 7
    v_lshl_add_u32 v200, v194, 3, s69
    v_lshl_add_u32 v26, v192, 10, v200
    v_lshl_add_u32 v27, v192, 12, v200
    v_subrev_u32 v27, 128, v27
    v_mul_u32_u24 v200, 28672, v193
    v_lshl_add_u32 v28, v195, 2, v200
    s_lshl_b32 s69, s64, 12
    v_lshl_add_u32 v29, v0, 4, s69
    v_lshl_add_u32 v199, v198, 1, v193
    v_bfe_u32 v200, v0, 1, 1
    v_bfe_u32 v201, v0, 2, 1
    v_lshl_add_u32 v202, v200, 1, v201
    v_xor_b32 v202, v202, v199
    v_lshl_add_u32 v202, v202, 1, v203
    s_add_u32 s69, s77, 32768
    v_lshl_add_u32 v202, v202, 4, s69
    v_lshl_add_u32 v30, v194, 7, v202
    v_xor_b32 v31, 16, v30
    s_movk_i32 s69, 16256
    v_mov_b32 v241, 0
    v_mov_b32 v242, 0
    v_mov_b32 v243, 0
    v_mov_b32 v245, 0
    v_mov_b32 v246, 0
    v_mov_b32 v247, 0
    v_mov_b32 v249, 0
    v_mov_b32 v250, 0
    v_mov_b32 v251, 0
    v_sub_u32 v248, 1, v193
    v_mul_u32_u24 v248, s69, v248
    s_mul_i32 s69, s62, 43
    s_lshr_b32 s69, s69, 7
    s_mul_i32 s70, s69, 3
    s_sub_u32 s68, s62, s70
    s_lshl1_add_u32 s68, s68, s66
    s_and_b32 s69, s69, 1
    s_xor_b32 s89, s66, s69
    s_lshl4_add_u32 s69, s89, s66
    s_lshl_b32 s69, s69, 10
    v_lshl_add_u32 v56, v0, 4, s69
    v_xor_b32 v57, 1024, v56
    v_lshl_add_u32 v201, v193, 3, v197
    v_lshl_add_u32 v201, v201, 4, v200
    v_lshrrev_b32 v202, 1, v197
    v_and_b32 v200, 1, v197
    v_lshl_add_u32 v200, v202, 2, v200
    v_lshl_add_u32 v200, v203, 1, v200
    v_xor_b32 v200, v200, v198
    v_lshl_add_u32 v201, v200, 1, v201
    v_lshlrev_b32 v201, 3, v201
    s_lshl_b32 s69, s89, 7
    s_add_u32 s69, s69, s66
    s_lshl_b32 s69, s69, 6
    s_add_u32 s69, s69, 32768
    v_xor_b32 v58, s69, v201
    v_xor_b32 v59, 544, v58
    v_xor_b32 v60, 64, v58
    v_xor_b32 v61, 608, v58
    s_cmp_eq_u32 s89, 0
    s_cselect_b64 s[12:13], s[14:15], s[16:17]
    s_cselect_b64 s[16:17], s[16:17], s[14:15]
    s_mul_i32 s81, s66, -98304
    s_add_u32 s81, s81, 49152
    s_mov_b32 s14, 0x62000
    s_mov_b32 s15, 0x20000
    s_mov_b32 s18, 0x62000
    s_mov_b32 s19, 0x20000
    s_mov_b32 s46, 0x188000
    s_mov_b32 s47, 0x20000
    s_mov_b32 s50, 0x380000
    s_mov_b32 s51, 0x20000
    s_lshl1_add_u32 s69, s63, s89
    s_mul_i32 s7, s69, 114688
    s_xor_b32 s69, s69, 1
    s_mul_i32 s10, s69, 114688
    s_lshl_b32 s32, s63, 7
    s_mul_i32 s78, s62, 84
    s_add_u32 s78, s78, 256
    s_mul_i32 s79, s62, 3584
    s_add_u32 s79, s79, 114688
    s_add_u32 s69, s63, s68
    s_cmp_ge_u32 s69, 6
    s_cselect_b32 s70, -6, 1
    s_add_u32 s69, s69, s70
    s_mul_i32 s70, s69, 12
    s_add_u32 s70, s70, s64
    s_add_u32 s70, s70, s78
    s_lshl_b32 s33, s70, 12
    s_lshl1_add_u32 s69, s69, s65
    s_mul_i32 s70, s69, 28672
    s_add_u32 s11, s70, s32
    s_lshl_b32 s69, s69, 6
    s_add_u32 s4, s69, s7
    s_add_u32 s8, s69, s10
    s_add_u32 s69, s69, s66
    s_lshl2_add_u32 s3, s69, s79
    s_add_u32 s68, s68, 2
    s_cmp_ge_u32 s68, 6
    s_cselect_b32 s70, 6, 0
    s_sub_u32 s68, s68, s70
    s_add_u32 s69, s63, s68
    s_cmp_ge_u32 s69, 6
    s_cselect_b32 s70, -6, 1
    s_add_u32 s69, s69, s70
    s_mul_i32 s70, s69, 12
    s_add_u32 s70, s70, s64
    s_add_u32 s70, s70, s78
    s_lshl_b32 s34, s70, 12
    s_add_u32 s34, s34, 16384
    s_lshl1_add_u32 s69, s69, s65
    s_mul_i32 s70, s69, 28672
    s_add_u32 s60, s70, s32
    s_lshl_b32 s69, s69, 6
    s_add_u32 s5, s69, s7
    s_add_u32 s9, s69, s10
    s_add_u32 s69, s69, s66
    s_lshl2_add_u32 s0, s69, s79
    s_add_u32 s68, s68, 2
    s_cmp_ge_u32 s68, 6
    s_cselect_b32 s70, 6, 0
    s_sub_u32 s68, s68, s70
    s_add_u32 s69, s63, s68
    s_cmp_ge_u32 s69, 6
    s_cselect_b32 s70, -6, 1
    s_add_u32 s69, s69, s70
    s_mul_i32 s70, s69, 12
    s_add_u32 s70, s70, s64
    s_add_u32 s70, s70, s78
    s_lshl_b32 s35, s70, 12
    s_add_u32 s35, s35, 32768
    s_lshl1_add_u32 s69, s69, s65
    s_mul_i32 s70, s69, 28672
    s_add_u32 s61, s70, s32
    buffer_load_dwordx4 v3, s[28:31], s83 offen offset:2048 lds
    buffer_load_dwordx4 v4, s[28:31], s83 offen offset:3072 lds
    s_add_u32 s84, s83, 128
    s_cmp_eq_u32 s84, 896
    s_cselect_b32 s84, 0, s84
    s_add_u32 m0, s77, 16384
    s_nop 0
    buffer_load_dwordx4 v204, s[20:23], s84 offen lds
    buffer_load_dwordx4 v205, s[20:23], s84 offen offset:1024 lds
    s_add_u32 m0, s67, 8192
    s_nop 0
    buffer_load_dwordx4 v1, s[24:27], s84 offen lds
    buffer_load_dwordx4 v2, s[24:27], s84 offen offset:1024 lds
    buffer_load_dwordx4 v3, s[28:31], s84 offen offset:2048 lds
    buffer_load_dwordx4 v4, s[28:31], s84 offen offset:3072 lds
    s_mov_b64 exec, 0
    s_cmp_eq_u32 s64, 0
    s_cbranch_scc1 L_pg1
    s_cmp_eq_u32 s64, 1
    s_cbranch_scc1 L_pg2
    s_cmp_eq_u32 s64, 2
    s_cbranch_scc1 L_pg3
    s_branch L_pg4
L_warm:
    s_mov_b64 exec, -1
    s_waitcnt vmcnt(22)
    s_barrier
    s_waitcnt vmcnt(18)
    ds_read_b128 v[208:211], v17 offset:0
    ds_read_b128 a[0:3], v13 offset:0
    ds_read_b128 a[112:115], v13 offset:4096
    ds_read_b128 v[224:227], v114 offset:0
    ds_read_b128 v[212:215], v18 offset:0
    ds_read_b128 a[4:7], v14 offset:0
    ds_read_b128 a[116:119], v14 offset:4096
    ds_read_b128 v[228:231], v112 offset:0
    s_waitcnt lgkmcnt(5)
    v_mfma_f32_32x32x16_bf16 v[64:79], a[0:3], v[208:211], 0
    ds_read_b128 v[216:219], v19 offset:0
    ds_read_b128 a[8:11], v15 offset:0
    s_add_u32 s85, s84, 128
    s_cmp_eq_u32 s85, 896
    s_cselect_b32 s85, 0, s85
    s_add_u32 m0, s77, 24576
    v_mfma_f32_32x32x16_bf16 v[80:95], a[112:115], v[208:211], 0
    ds_read_b128 a[120:123], v15 offset:4096
    ds_read_b128 v[232:235], v114 offset:64
    buffer_load_dwordx4 v204, s[20:23], s85 offen lds
    s_lshl_b32 s69, s69, 6
    s_waitcnt lgkmcnt(4)
    v_mfma_f32_32x32x16_bf16 v[64:79], a[4:7], v[212:215], v[64:79]
    ds_read_b128 v[220:223], v20 offset:0
    ds_read_b128 a[12:15], v16 offset:0
    buffer_load_dwordx4 v205, s[20:23], s85 offen offset:1024 lds
    s_add_u32 s6, s69, s7
    s_add_u32 s10, s69, s10
    s_add_u32 m0, s67, 12288
    v_mfma_f32_32x32x16_bf16 v[80:95], a[116:119], v[212:215], v[80:95]
    ds_read_b128 a[124:127], v16 offset:4096
    ds_read_b128 v[236:239], v113 offset:0
    buffer_load_dwordx4 v1, s[24:27], s85 offen lds
    s_add_u32 s69, s69, s66
    s_lshl2_add_u32 s1, s69, s79
    v_mfma_f32_16x16x32_bf16 v[96:99], v[224:227], v[228:231], 0
    s_mul_i32 s70, s63, 12
    s_waitcnt vmcnt(13)
    s_barrier
    s_waitcnt vmcnt(9) lgkmcnt(5)
    v_mfma_f32_32x32x16_bf16 v[64:79], a[8:11], v[216:219], v[64:79]
    ds_read_b128 v[208:211], v17 offset:4096
    ds_read_b128 a[16:19], v13 offset:8192
    s_add_u32 s70, s70, s65
    s_add_u32 s70, s70, s78
    s_lshl_b32 s78, s70, 12
    v_mfma_f32_32x32x16_bf16 v[80:95], a[120:123], v[216:219], v[80:95]
    ds_read_b128 a[128:131], v13 offset:12288
    ds_read_b128 v[224:227], v114 offset:128
    buffer_load_dwordx4 v2, s[24:27], s85 offen offset:1024 lds
    s_lshl2_add_u32 s79, s80, s79
    s_waitcnt lgkmcnt(4)
    v_mfma_f32_32x32x16_bf16 v[64:79], a[12:15], v[220:223], v[64:79]
    ds_read_b128 v[212:215], v18 offset:4096
    ds_read_b128 a[20:23], v14 offset:8192
    s_add_u32 s7, s7, s80
    s_mul_i32 s70, s80, 448
    s_add_u32 s32, s32, s70
    v_mfma_f32_32x32x16_bf16 v[80:95], a[124:127], v[220:223], v[80:95]
    ds_read_b128 a[132:135], v14 offset:12288
    ds_read_b128 v[228:231], v112 offset:8192
    buffer_load_dwordx4 v3, s[28:31], s85 offen offset:2048 lds
    s_lshl1_add_u32 s69, s62, s66
    s_mul_i32 s69, s69, 57344
    s_lshl1_add_u32 s80, s80, s69
    v_mfma_f32_16x16x32_bf16 v[96:99], v[232:235], v[236:239], v[96:99]
    s_waitcnt lgkmcnt(5)
    v_mfma_f32_32x32x16_bf16 v[64:79], a[16:19], v[208:211], v[64:79]
    ds_read_b128 v[216:219], v19 offset:4096
    ds_read_b128 a[24:27], v15 offset:8192
    buffer_load_dwordx4 v4, s[28:31], s85 offen offset:3072 lds
    s_add_u32 s86, s85, 128
    s_cmp_eq_u32 s86, 896
    s_cselect_b32 s86, 0, s86
    s_add_u32 m0, s77, 32768
    v_mfma_f32_32x32x16_bf16 v[80:95], a[128:131], v[208:211], v[80:95]
    ds_read_b128 a[136:139], v15 offset:12288
    ds_read_b128 v[232:235], v114 offset:192
    buffer_load_dwordx4 v204, s[20:23], s86 offen lds
    v_lshlrev_b32 v122, 16, v122
    v_mul_f32 v122, s72, v122
    s_waitcnt lgkmcnt(4)
    v_mfma_f32_32x32x16_bf16 v[64:79], a[20:23], v[212:215], v[64:79]
    ds_read_b128 v[220:223], v20 offset:4096
    ds_read_b128 a[28:31], v16 offset:8192
    v_exp_f32 v122, v122
    v_lshlrev_b32 v120, 16, v120
    v_mfma_f32_32x32x16_bf16 v[80:95], a[132:135], v[212:215], v[80:95]
    ds_read_b128 a[140:143], v16 offset:12288
    ds_read_b128 v[236:239], v113 offset:8192
    buffer_load_dwordx4 v205, s[20:23], s86 offen offset:1024 lds
    v_lshlrev_b32 v121, 16, v121
    v_cvt_pk_bf16_f32 v122, v122, v122
    v_mfma_f32_16x16x32_bf16 v[96:99], v[224:227], v[228:231], v[96:99]
    v_lshlrev_b32 v122, 16, v122
    s_waitcnt vmcnt(12)
    s_barrier
    s_waitcnt vmcnt(8) lgkmcnt(5)
    v_mfma_f32_32x32x16_bf16 v[64:79], a[24:27], v[216:219], v[64:79]
    ds_read_b128 v[208:211], v17 offset:8192
    ds_read_b128 a[32:35], v13 offset:16384
    v_mul_f32 v123, v122, v120
    v_mul_f32 v123, s72, v123
    s_add_u32 m0, s67, 16384
    v_mfma_f32_32x32x16_bf16 v[80:95], a[136:139], v[216:219], v[80:95]
    ds_read_b128 a[144:147], v13 offset:20480
    ds_read_b128 v[224:227], v114 offset:256
    buffer_load_dwordx4 v1, s[24:27], s86 offen lds
    v_mul_f32 v124, v122, v121
    v_mul_f32 v124, 0.15915494, v124
    s_waitcnt lgkmcnt(4)
    v_mfma_f32_32x32x16_bf16 v[64:79], a[28:31], v[220:223], v[64:79]
    ds_read_b128 v[212:215], v18 offset:8192
    ds_read_b128 a[36:39], v14 offset:16384
    v_mul_f32 v200, 1.0, v123
    v_mul_f32 v201, 1.0, v124
    v_mfma_f32_32x32x16_bf16 v[80:95], a[140:143], v[220:223], v[80:95]
    ds_read_b128 a[148:151], v14 offset:20480
    ds_read_b128 v[228:231], v112 offset:16384
    buffer_load_dwordx4 v2, s[24:27], s86 offen offset:1024 lds
    v_exp_f32 v200, v200
    v_rndne_f32 v202, v201
    v_mfma_f32_16x16x32_bf16 v[96:99], v[232:235], v[236:239], v[96:99]
    v_sub_f32 v201, v201, v202
    s_waitcnt lgkmcnt(5)
    v_mfma_f32_32x32x16_bf16 v[64:79], a[32:35], v[208:211], v[64:79]
    ds_read_b128 v[216:219], v19 offset:8192
    ds_read_b128 a[40:43], v15 offset:16384
    buffer_load_dwordx4 v3, s[28:31], s86 offen offset:2048 lds
    v_cos_f32 v32, v201
    v_mfma_f32_32x32x16_bf16 v[80:95], a[144:147], v[208:211], v[80:95]
    ds_read_b128 a[152:155], v15 offset:20480
    ds_read_b128 v[232:235], v114 offset:320
    buffer_load_dwordx4 v4, s[28:31], s86 offen offset:3072 lds
    v_sin_f32 v33, v201
    s_waitcnt lgkmcnt(4)
    v_mfma_f32_32x32x16_bf16 v[64:79], a[36:39], v[212:215], v[64:79]
    ds_read_b128 v[220:223], v20 offset:8192
    ds_read_b128 a[44:47], v16 offset:16384
    s_add_u32 s87, s86, 128
    s_cmp_eq_u32 s87, 896
    s_cselect_b32 s87, 0, s87
    s_add_u32 m0, s77, 40960
    v_mfma_f32_32x32x16_bf16 v[80:95], a[148:151], v[212:215], v[80:95]
    ds_read_b128 a[156:159], v16 offset:20480
    ds_read_b128 v[236:239], v113 offset:16384
    buffer_load_dwordx4 v204, s[20:23], s87 offen lds
    v_mul_f32 v32, v200, v32
    v_mul_f32 v33, v200, v33
    v_mfma_f32_16x16x32_bf16 v[96:99], v[224:227], v[228:231], v[96:99]
    v_mul_f32 v200, 0x41800000, v123
    s_waitcnt vmcnt(11)
    s_barrier
    s_waitcnt vmcnt(7) lgkmcnt(5)
    v_mfma_f32_32x32x16_bf16 v[64:79], a[40:43], v[216:219], v[64:79]
    ds_read_b128 v[208:211], v17 offset:12288
    ds_read_b128 a[48:51], v13 offset:24576
    v_mul_f32 v201, 0x41800000, v124
    v_exp_f32 v200, v200
    v_mfma_f32_32x32x16_bf16 v[80:95], a[152:155], v[216:219], v[80:95]
    ds_read_b128 a[160:163], v13 offset:28672
    ds_read_b128 v[224:227], v114 offset:384
    buffer_load_dwordx4 v205, s[20:23], s87 offen offset:1024 lds
    v_rndne_f32 v202, v201
    s_add_u32 m0, s67, 20480
    s_waitcnt lgkmcnt(4)
    v_mfma_f32_32x32x16_bf16 v[64:79], a[44:47], v[220:223], v[64:79]
    ds_read_b128 v[212:215], v18 offset:12288
    ds_read_b128 a[52:55], v14 offset:24576
    buffer_load_dwordx4 v1, s[24:27], s87 offen lds
    v_sub_f32 v201, v201, v202
    v_mfma_f32_32x32x16_bf16 v[80:95], a[156:159], v[220:223], v[80:95]
    ds_read_b128 a[164:167], v14 offset:28672
    ds_read_b128 v[228:231], v112 offset:24576
    buffer_load_dwordx4 v2, s[24:27], s87 offen offset:1024 lds
    v_cos_f32 v34, v201
    v_mfma_f32_16x16x32_bf16 v[96:99], v[232:235], v[236:239], v[96:99]
    v_sin_f32 v35, v201
    s_waitcnt lgkmcnt(5)
L_pg1:
    s_cbranch_execz L_warm
    v_mfma_f32_32x32x16_bf16 v[64:79], a[48:51], v[208:211], v[64:79]
    ds_read_b128 v[216:219], v19 offset:12288
    ds_read_b128 a[56:59], v15 offset:24576
    v_mul_f32 v34, v200, v34
    v_mul_f32 v35, v200, v35
    v_mul_f32 v36, v34, v34
    v_mfma_f32_32x32x16_bf16 v[80:95], a[160:163], v[208:211], v[80:95]
    ds_read_b128 a[168:171], v15 offset:28672
    ds_read_b128 v[232:235], v114 offset:448
    buffer_load_dwordx4 v3, s[28:31], s87 offen offset:2048 lds
    v_mul_f32 v37, v34, v35
    v_fma_f32 v36, -v35, v35, v36
    s_waitcnt lgkmcnt(4)
    v_mfma_f32_32x32x16_bf16 v[64:79], a[52:55], v[212:215], v[64:79]
    ds_read_b128 v[220:223], v20 offset:12288
    ds_read_b128 a[60:63], v16 offset:24576
    v_fmac_f32 v37, v35, v34
    v_mul_f32 v38, v36, v36
    v_mul_f32 v39, v36, v37
    v_mfma_f32_32x32x16_bf16 v[80:95], a[164:167], v[212:215], v[80:95]
    ds_read_b128 a[172:175], v16 offset:28672
    ds_read_b128 v[236:239], v113 offset:24576
    buffer_load_dwordx4 v4, s[28:31], s87 offen offset:3072 lds
    v_fma_f32 v38, -v37, v37, v38
    v_fmac_f32 v39, v37, v36
    v_mfma_f32_16x16x32_bf16 v[96:99], v[224:227], v[228:231], v[96:99]
    s_add_u32 s88, s87, 128
    s_cmp_eq_u32 s88, 896
    s_cselect_b32 s88, 0, s88
    s_add_u32 m0, s77, 49152
    s_waitcnt vmcnt(10)
    s_barrier
    s_waitcnt vmcnt(6) lgkmcnt(5)
    v_mfma_f32_32x32x16_bf16 v[64:79], a[56:59], v[216:219], v[64:79]
    ds_read_b128 v[208:211], v17 offset:16384
    ds_read_b128 a[64:67], v13 offset:32768
    buffer_load_dwordx4 v204, s[20:23], s88 offen lds
    v_lshlrev_b32 v125, 9, v192
    v_cvt_f32_u32 v125, v125
    v_mfma_f32_32x32x16_bf16 v[80:95], a[168:171], v[216:219], v[80:95]
    ds_read_b128 a[176:179], v13 offset:36864
    ds_read_b128 v[224:227], v114 offset:512
    buffer_load_dwordx4 v205, s[20:23], s88 offen offset:1024 lds
    v_mul_f32 v200, v125, v123
    v_mul_f32 v201, v125, v124
    s_waitcnt lgkmcnt(4)
    v_mfma_f32_32x32x16_bf16 v[64:79], a[60:63], v[220:223], v[64:79]
    ds_read_b128 v[212:215], v18 offset:16384
    ds_read_b128 a[68:71], v14 offset:32768
    v_exp_f32 v200, v200
    s_add_u32 m0, s67, 0
    v_mfma_f32_32x32x16_bf16 v[80:95], a[172:175], v[220:223], v[80:95]
    ds_read_b128 a[180:183], v14 offset:36864
    ds_read_b128 v[228:231], v112 offset:32768
    buffer_load_dwordx4 v1, s[24:27], s88 offen lds
    v_rndne_f32 v202, v201
    v_sub_f32 v201, v201, v202
    v_mfma_f32_16x16x32_bf16 v[96:99], v[232:235], v[236:239], v[96:99]
    s_waitcnt lgkmcnt(5)
    v_mfma_f32_32x32x16_bf16 v[64:79], a[64:67], v[208:211], v[64:79]
    ds_read_b128 v[216:219], v19 offset:16384
    ds_read_b128 a[72:75], v15 offset:32768
    v_cos_f32 v40, v201
    v_sin_f32 v41, v201
    v_mfma_f32_32x32x16_bf16 v[80:95], a[176:179], v[208:211], v[80:95]
    ds_read_b128 a[184:187], v15 offset:36864
    ds_read_b128 v[232:235], v114 offset:576
    buffer_load_dwordx4 v2, s[24:27], s88 offen offset:1024 lds
    v_mul_f32 v40, v200, v40
    v_mul_f32 v41, v200, v41
    s_waitcnt lgkmcnt(4)
    v_mfma_f32_32x32x16_bf16 v[64:79], a[68:71], v[212:215], v[64:79]
    ds_read_b128 v[220:223], v20 offset:16384
    ds_read_b128 a[76:79], v16 offset:32768
    v_cvt_f32_u32 v46, v193
    v_cvt_f32_u32 v125, v198
    v_add_f32 v200, -1.0, v34
    v_mfma_f32_32x32x16_bf16 v[80:95], a[180:183], v[212:215], v[80:95]
    ds_read_b128 a[188:191], v16 offset:36864
    ds_read_b128 v[236:239], v113 offset:32768
    buffer_load_dwordx4 v3, s[28:31], s88 offen offset:2048 lds
    v_fma_f32 v44, v46, v200, 1.0
    v_mul_f32 v45, v46, v35
    v_mfma_f32_16x16x32_bf16 v[96:99], v[224:227], v[228:231], v[96:99]
    v_add_f32 v200, -1.0, v36
    s_waitcnt vmcnt(9)
    s_barrier
    s_waitcnt vmcnt(5) lgkmcnt(5)
    v_mfma_f32_32x32x16_bf16 v[64:79], a[72:75], v[216:219], v[64:79]
    ds_read_b128 v[208:211], v17 offset:20480
    ds_read_b128 a[80:83], v13 offset:40960
    buffer_load_dwordx4 v4, s[28:31], s88 offen offset:3072 lds
    v_fma_f32 v200, v125, v200, 1.0
    s_add_u32 m0, s67, 4096
    s_mul_i32 s82, s82, 1792
    v_mfma_f32_32x32x16_bf16 v[80:95], a[184:187], v[216:219], v[80:95]
    ds_read_b128 a[192:195], v13 offset:45056
    ds_read_b128 v[224:227], v114 offset:640
    buffer_load_dwordx4 v5, s[40:43], s82 offen lds
    v_mul_f32 v201, v125, v37
    s_waitcnt lgkmcnt(4)
    v_mfma_f32_32x32x16_bf16 v[64:79], a[76:79], v[220:223], v[64:79]
    ds_read_b128 v[212:215], v18 offset:20480
    ds_read_b128 a[84:87], v14 offset:40960
    v_mul_f32 v50, v200, v44
    v_mul_f32 v51, v200, v45
    v_fma_f32 v50, -v201, v45, v50
    v_mfma_f32_32x32x16_bf16 v[80:95], a[188:191], v[220:223], v[80:95]
    ds_read_b128 a[196:199], v14 offset:45056
    ds_read_b128 v[228:231], v112 offset:40960
    buffer_load_dwordx4 v6, s[40:43], s82 offen offset:1024 lds
    v_fmac_f32 v51, v201, v44
    v_mul_f32 v44, v125, v44
    v_mul_f32 v45, v125, v45
    v_mfma_f32_16x16x32_bf16 v[96:99], v[232:235], v[236:239], v[96:99]
    s_waitcnt lgkmcnt(5)
    v_mfma_f32_32x32x16_bf16 v[64:79], a[80:83], v[208:211], v[64:79]
    ds_read_b128 v[216:219], v19 offset:20480
    ds_read_b128 a[88:91], v15 offset:40960
    v_mul_f32 v200, v120, v120
    v_fmac_f32 v200, v121, v121
    v_mfma_f32_32x32x16_bf16 v[80:95], a[192:195], v[208:211], v[80:95]
    ds_read_b128 a[200:203], v15 offset:45056
    ds_read_b128 v[232:235], v114 offset:704
    buffer_load_dwordx4 v7, s[40:43], s82 offen offset:2048 lds
    v_rcp_f32 v200, v200
    v_add_f32 v201, -1.0, v32
    s_waitcnt lgkmcnt(4)
    v_mfma_f32_32x32x16_bf16 v[64:79], a[84:87], v[212:215], v[64:79]
    ds_read_b128 v[220:223], v20 offset:20480
    ds_read_b128 a[92:95], v16 offset:40960
    buffer_load_dwordx4 v8, s[40:43], s82 offen offset:3072 lds
    v_add_f32 v200, v200, v200
    s_add_u32 m0, s67, 8192
    s_mul_i32 s83, s83, 1792
    v_mfma_f32_32x32x16_bf16 v[80:95], a[196:199], v[212:215], v[80:95]
    ds_read_b128 a[204:207], v16 offset:45056
    ds_read_b128 v[236:239], v113 offset:40960
    buffer_load_dwordx4 v5, s[40:43], s83 offen lds
    v_mul_f32 v48, v201, v120
    v_fmac_f32 v48, v33, v121
    v_mfma_f32_16x16x32_bf16 v[96:99], v[224:227], v[228:231], v[96:99]
    v_mul_f32 v49, v33, v120
    s_waitcnt vmcnt(9)
    s_barrier
    s_waitcnt vmcnt(5) lgkmcnt(5)
    v_mfma_f32_32x32x16_bf16 v[64:79], a[88:91], v[216:219], v[64:79]
    ds_read_b128 v[208:211], v17 offset:0
    ds_read_b128 a[96:99], v13 offset:49152
    v_fma_f32 v49, -v201, v121, v49
    v_mul_f32 v48, v200, v48
    v_mul_f32 v49, v200, v49
    v_mfma_f32_32x32x16_bf16 v[80:95], a[200:203], v[216:219], v[80:95]
    ds_read_b128 a[208:211], v13 offset:53248
    ds_read_b128 v[224:227], v114 offset:768
    buffer_load_dwordx4 v6, s[40:43], s83 offen offset:1024 lds
    v_mul_f32 v42, v48, v50
    s_waitcnt lgkmcnt(4)
    v_mfma_f32_32x32x16_bf16 v[64:79], a[92:95], v[220:223], v[64:79]
    ds_read_b128 v[212:215], v18 offset:0
    ds_read_b128 a[100:103], v14 offset:49152
    v_mul_f32 v43, v48, v51
    v_fma_f32 v42, -v49, v51, v42
    v_fmac_f32 v43, v49, v50
    v_lshlrev_b32 v47, 16, v47
    v_mfma_f32_32x32x16_bf16 v[80:95], a[204:207], v[220:223], v[80:95]
    ds_read_b128 a[212:215], v14 offset:53248
    ds_read_b128 v[228:231], v112 offset:49152
    buffer_load_dwordx4 v7, s[40:43], s83 offen offset:2048 lds
    ds_read_b64_tr_b16 v[200:201], v116 offset:0
    ds_read_b64_tr_b16 v[202:203], v117 offset:1024
    ds_read_b64_tr_b16 v[204:205], v116 offset:2048
    v_mfma_f32_16x16x32_bf16 v[96:99], v[232:235], v[236:239], v[96:99]
    ds_read_b64_tr_b16 v[206:207], v117 offset:3072
    s_waitcnt lgkmcnt(9)
    v_mfma_f32_32x32x16_bf16 v[64:79], a[96:99], v[208:211], v[64:79]
    ds_read_b128 v[216:219], v19 offset:0
    ds_read_b128 a[104:107], v15 offset:49152
    buffer_load_dwordx4 v8, s[40:43], s83 offen offset:3072 lds
    buffer_load_dword v253, v255, s[56:59], 0 offen sc1
    s_add_u32 m0, s67, 12288
    s_mul_i32 s84, s84, 1792
    v_mfma_f32_32x32x16_bf16 v[80:95], a[208:211], v[208:211], v[80:95]
    ds_read_b128 a[216:219], v15 offset:53248
    ds_read_b128 v[232:235], v114 offset:832
    buffer_load_dwordx4 v5, s[40:43], s84 offen lds
    v_subrev_u32 v1, s76, v1
    v_subrev_u32 v2, s76, v2
    s_waitcnt lgkmcnt(8)
    v_mfma_f32_32x32x16_bf16 v[64:79], a[100:103], v[212:215], v[64:79]
    ds_read_b128 v[220:223], v20 offset:0
    ds_read_b128 a[108:111], v16 offset:49152
    v_subrev_u32 v3, s76, v3
    v_subrev_u32 v4, s76, v4
    v_mfma_f32_32x32x16_bf16 v[80:95], a[212:215], v[212:215], v[80:95]
    ds_read_b128 a[220:223], v16 offset:53248
    ds_read_b128 v[236:239], v113 offset:49152
    buffer_load_dwordx4 v6, s[40:43], s84 offen offset:1024 lds
    v_mfma_f32_16x16x32_bf16 v[96:99], v[224:227], v[228:231], v[96:99]
    s_waitcnt vmcnt(10) lgkmcnt(5)
    v_mfma_f32_32x32x16_bf16 v[64:79], a[104:107], v[216:219], v[64:79]
    ds_read_b64_tr_b16 v[208:209], v21 offset:4096
    ds_read_b64_tr_b16 v[210:211], v21 offset:4352
    v_mfma_f32_32x32x16_bf16 v[80:95], a[216:219], v[216:219], v[80:95]
    buffer_load_dwordx4 v7, s[40:43], s84 offen offset:2048 lds
    s_waitcnt vmcnt(10) lgkmcnt(2)
    v_mfma_f32_32x32x16_bf16 v[64:79], a[108:111], v[220:223], v[64:79]
    ds_read_b64_tr_b16 v[212:213], v21 offset:5120
    ds_read_b64_tr_b16 v[214:215], v21 offset:5376
    v_mfma_f32_32x32x16_bf16 v[80:95], a[220:223], v[220:223], v[80:95]
    buffer_load_dwordx4 v8, s[40:43], s84 offen offset:3072 lds
    v_mfma_f32_16x16x32_bf16 v[96:99], v[232:235], v[236:239], v[96:99]
    v_mfma_f32_32x32x16_bf16 v[128:143], v[240:243], v[248:251], 0
    v_mfma_f32_32x32x16_bf16 v[144:159], v[240:243], v[248:251], 0
    s_nop 5
    v_cvt_pk_bf16_f32 v100, v96, v96
    v_lshlrev_b32 v100, 16, v100
    v_mul_f32 v100, s72, v100
    v_exp_f32 v100, -v100
    s_nop 0
    v_add_f32 v100, 1.0, v100
    v_mfma_f32_32x32x16_bf16 v[160:175], v[244:247], v[248:251], 0
    v_rcp_f32 v100, v100
    s_nop 0
    v_cvt_pk_bf16_f32 v100, v100, v100
    v_lshlrev_b32 v100, 16, v100
    v_sub_f32 v101, 1.0, v100
    v_cvt_pk_bf16_f32 v101, v101, v101
    v_mfma_f32_32x32x16_bf16 v[176:191], v[244:247], v[248:251], 0
    v_lshlrev_b32 v101, 16, v101
    ds_write2_b32 v115, v100, v101 offset1:64
    v_permlane16_swap_b32 v64, v80
    v_permlane16_swap_b32 v65, v81
    v_permlane16_swap_b32 v66, v82
    v_permlane16_swap_b32 v67, v83
    s_waitcnt lgkmcnt(0)
    s_barrier
    s_waitcnt vmcnt(10)
    v_mfma_f32_32x32x16_bf16 v[128:143], v[208:211], a[0:3], v[128:143]
    ds_read_b64_tr_b16 v[216:217], v21 offset:6144
    ds_read_b64_tr_b16 v[218:219], v21 offset:6400
    v_permlane16_swap_b32 v68, v84
    s_add_u32 m0, s67, 16384
    s_mul_i32 s85, s85, 1792
    v_mfma_f32_32x32x16_bf16 v[144:159], v[208:211], a[112:115], v[144:159]
    buffer_load_dwordx4 v5, s[40:43], s85 offen lds
    v_permlane16_swap_b32 v69, v85
    v_permlane16_swap_b32 v70, v86
    s_waitcnt vmcnt(10)
    v_mfma_f32_32x32x16_bf16 v[128:143], v[212:215], a[4:7], v[128:143]
    ds_read_b64_tr_b16 v[220:221], v21 offset:7168
    ds_read_b64_tr_b16 v[222:223], v21 offset:7424
    buffer_load_dwordx4 v6, s[40:43], s85 offen offset:1024 lds
    v_permlane16_swap_b32 v71, v87
    v_mfma_f32_32x32x16_bf16 v[144:159], v[212:215], a[116:119], v[144:159]
    buffer_load_dwordx4 v7, s[40:43], s85 offen offset:2048 lds
    v_permlane16_swap_b32 v72, v88
    v_permlane16_swap_b32 v73, v89
    s_waitcnt vmcnt(11) lgkmcnt(2)
    v_mfma_f32_32x32x16_bf16 v[128:143], v[216:219], a[8:11], v[128:143]
    ds_read_b64_tr_b16 v[208:209], v21 offset:8192
    ds_read_b64_tr_b16 v[210:211], v21 offset:8448
    v_permlane16_swap_b32 v74, v90
    v_permlane16_swap_b32 v75, v91
    v_mfma_f32_32x32x16_bf16 v[144:159], v[216:219], a[120:123], v[144:159]
    buffer_load_dwordx4 v8, s[40:43], s85 offen offset:3072 lds
    v_permlane16_swap_b32 v76, v92
    v_permlane16_swap_b32 v77, v93
    s_waitcnt vmcnt(11) lgkmcnt(2)
    v_mfma_f32_32x32x16_bf16 v[128:143], v[220:223], a[12:15], v[128:143]
    ds_read_b64_tr_b16 v[212:213], v21 offset:9216
    ds_read_b64_tr_b16 v[214:215], v21 offset:9472
    v_permlane16_swap_b32 v78, v94
    s_add_u32 m0, s67, 20480
    s_mul_i32 s86, s86, 1792
    v_mfma_f32_32x32x16_bf16 v[144:159], v[220:223], a[124:127], v[144:159]
    buffer_load_dwordx4 v5, s[40:43], s86 offen lds
    v_permlane16_swap_b32 v79, v95
    v_fma_f32 v242, v32, v64, v65
    v_fma_f32 v243, v32, v80, v81
    v_fma_f32 v242, -v33, v80, v242
    s_waitcnt vmcnt(11) lgkmcnt(2)
    v_mfma_f32_32x32x16_bf16 v[128:143], v[208:211], a[16:19], v[128:143]
    ds_read_b64_tr_b16 v[216:217], v21 offset:10240
    ds_read_b64_tr_b16 v[218:219], v21 offset:10496
    v_fmac_f32 v243, v33, v64
    v_fma_f32 v240, v32, v242, v66
    v_fma_f32 v241, v32, v243, v82
    v_fma_f32 v240, -v33, v243, v240
    v_mfma_f32_32x32x16_bf16 v[144:159], v[208:211], a[128:131], v[144:159]
    buffer_load_dwordx4 v6, s[40:43], s86 offen offset:1024 lds
    v_fmac_f32 v241, v33, v242
    v_fma_f32 v242, v32, v240, v67
    v_fma_f32 v243, v32, v241, v83
    v_fma_f32 v242, -v33, v241, v242
    s_waitcnt vmcnt(11) lgkmcnt(2)
    v_mfma_f32_32x32x16_bf16 v[128:143], v[212:215], a[20:23], v[128:143]
    ds_read_b64_tr_b16 v[220:221], v21 offset:11264
    ds_read_b64_tr_b16 v[222:223], v21 offset:11520
    v_fmac_f32 v243, v33, v240
    v_fma_f32 v240, v32, v242, v68
    v_fma_f32 v241, v32, v243, v84
    v_fma_f32 v240, -v33, v243, v240
    v_mfma_f32_32x32x16_bf16 v[144:159], v[212:215], a[132:135], v[144:159]
    buffer_load_dwordx4 v7, s[40:43], s86 offen offset:2048 lds
    v_fmac_f32 v241, v33, v242
    v_fma_f32 v242, v32, v240, v69
    v_fma_f32 v243, v32, v241, v85
    v_fma_f32 v242, -v33, v241, v242
    s_waitcnt vmcnt(10) lgkmcnt(2)
    v_mfma_f32_32x32x16_bf16 v[128:143], v[216:219], a[24:27], v[128:143]
    ds_read_b64_tr_b16 v[208:209], v21 offset:12288
    ds_read_b64_tr_b16 v[210:211], v21 offset:12544
    v_fmac_f32 v243, v33, v240
    v_fma_f32 v240, v32, v242, v70
    v_fma_f32 v241, v32, v243, v86
    v_fma_f32 v240, -v33, v243, v240
    v_mfma_f32_32x32x16_bf16 v[144:159], v[216:219], a[136:139], v[144:159]
    buffer_load_dwordx4 v8, s[40:43], s86 offen offset:3072 lds
    v_fmac_f32 v241, v33, v242
    v_fma_f32 v242, v32, v240, v71
    v_fma_f32 v243, v32, v241, v87
    v_fma_f32 v242, -v33, v241, v242
    s_waitcnt vmcnt(10) lgkmcnt(2)
    v_mfma_f32_32x32x16_bf16 v[128:143], v[220:223], a[28:31], v[128:143]
    ds_read_b64_tr_b16 v[212:213], v21 offset:13312
    ds_read_b64_tr_b16 v[214:215], v21 offset:13568
    v_fmac_f32 v243, v33, v240
    v_fma_f32 v240, v32, v242, v72
    s_add_u32 m0, s67, 0
    s_mul_i32 s87, s87, 1792
    v_mfma_f32_32x32x16_bf16 v[144:159], v[220:223], a[140:143], v[144:159]
    buffer_load_dwordx4 v5, s[40:43], s87 offen lds
    v_fma_f32 v241, v32, v243, v88
    v_fma_f32 v240, -v33, v243, v240
    v_fmac_f32 v241, v33, v242
    v_fma_f32 v242, v32, v240, v73
    s_waitcnt vmcnt(10) lgkmcnt(2)
    v_mfma_f32_32x32x16_bf16 v[128:143], v[208:211], a[32:35], v[128:143]
    ds_read_b64_tr_b16 v[216:217], v21 offset:14336
    ds_read_b64_tr_b16 v[218:219], v21 offset:14592
    v_fma_f32 v243, v32, v241, v89
    v_fma_f32 v242, -v33, v241, v242
    v_fmac_f32 v243, v33, v240
    v_fma_f32 v240, v32, v242, v74
    v_mfma_f32_32x32x16_bf16 v[144:159], v[208:211], a[144:147], v[144:159]
    buffer_load_dwordx4 v6, s[40:43], s87 offen offset:1024 lds
    v_fma_f32 v241, v32, v243, v90
    v_fma_f32 v240, -v33, v243, v240
    v_fmac_f32 v241, v33, v242
    v_fma_f32 v242, v32, v240, v75
    s_waitcnt vmcnt(10) lgkmcnt(2)
    v_mfma_f32_32x32x16_bf16 v[128:143], v[212:215], a[36:39], v[128:143]
    ds_read_b64_tr_b16 v[220:221], v21 offset:15360
    ds_read_b64_tr_b16 v[222:223], v21 offset:15616
    v_fma_f32 v243, v32, v241, v91
    v_fma_f32 v242, -v33, v241, v242
    v_fmac_f32 v243, v33, v240
    v_fma_f32 v240, v32, v242, v76
    v_mfma_f32_32x32x16_bf16 v[144:159], v[212:215], a[148:151], v[144:159]
    buffer_load_dwordx4 v7, s[40:43], s87 offen offset:2048 lds
    v_fma_f32 v241, v32, v243, v92
    v_fma_f32 v240, -v33, v243, v240
    v_fmac_f32 v241, v33, v242
    v_fma_f32 v242, v32, v240, v77
    s_waitcnt vmcnt(10) lgkmcnt(2)
    v_mfma_f32_32x32x16_bf16 v[128:143], v[216:219], a[40:43], v[128:143]
    ds_read_b64_tr_b16 v[208:209], v21 offset:16384
    ds_read_b64_tr_b16 v[210:211], v21 offset:16640
    v_fma_f32 v243, v32, v241, v93
    v_fma_f32 v242, -v33, v241, v242
    v_fmac_f32 v243, v33, v240
    v_fma_f32 v240, v32, v242, v78
    v_mfma_f32_32x32x16_bf16 v[144:159], v[216:219], a[152:155], v[144:159]
    buffer_load_dwordx4 v8, s[40:43], s87 offen offset:3072 lds
    v_fma_f32 v241, v32, v243, v94
    v_fma_f32 v240, -v33, v243, v240
    v_fmac_f32 v241, v33, v242
    v_fma_f32 v242, v32, v240, v79
    s_waitcnt vmcnt(10) lgkmcnt(2)
    v_mfma_f32_32x32x16_bf16 v[128:143], v[220:223], a[44:47], v[128:143]
    ds_read_b64_tr_b16 v[212:213], v21 offset:17408
    ds_read_b64_tr_b16 v[214:215], v21 offset:17664
    v_fma_f32 v243, v32, v241, v95
    v_fma_f32 v242, -v33, v241, v242
    s_add_u32 m0, s67, 4096
    s_mul_i32 s88, s88, 1792
    v_mfma_f32_32x32x16_bf16 v[144:159], v[220:223], a[156:159], v[144:159]
    buffer_load_dwordx4 v5, s[40:43], s88 offen lds
    v_fmac_f32 v243, v33, v240
    v_mov_b32 v240, v242
    v_mov_b32 v241, v243
    s_waitcnt vmcnt(10) lgkmcnt(2)
    v_mfma_f32_32x32x16_bf16 v[128:143], v[208:211], a[48:51], v[128:143]
    ds_read_b64_tr_b16 v[216:217], v21 offset:18432
    ds_read_b64_tr_b16 v[218:219], v21 offset:18688
    v_permlane32_swap_b32 v242, v240
    v_permlane32_swap_b32 v243, v241
    v_fma_f32 v244, v34, v242, v240
    v_mfma_f32_32x32x16_bf16 v[144:159], v[208:211], a[160:163], v[144:159]
    buffer_load_dwordx4 v6, s[40:43], s88 offen offset:1024 lds
    v_fma_f32 v245, v34, v243, v241
    v_fma_f32 v244, -v35, v243, v244
    v_fmac_f32 v245, v35, v242
    v_mov_b32 v246, v244
    s_waitcnt vmcnt(10) lgkmcnt(2)
    v_mfma_f32_32x32x16_bf16 v[128:143], v[212:215], a[52:55], v[128:143]
    ds_read_b64_tr_b16 v[220:221], v21 offset:19456
    ds_read_b64_tr_b16 v[222:223], v21 offset:19712
    v_mov_b32 v247, v245
    v_permlane16_swap_b32 v244, v246
    v_mfma_f32_32x32x16_bf16 v[144:159], v[212:215], a[164:167], v[144:159]
    buffer_load_dwordx4 v7, s[40:43], s88 offen offset:2048 lds
    v_permlane16_swap_b32 v245, v247
    v_fma_f32 v248, v36, v244, v246
    v_fma_f32 v249, v36, v245, v247
    v_fma_f32 v248, -v37, v245, v248
    s_waitcnt vmcnt(10) lgkmcnt(2)
    v_mfma_f32_32x32x16_bf16 v[128:143], v[216:219], a[56:59], v[128:143]
    ds_read_b64_tr_b16 v[208:209], v21 offset:20480
    ds_read_b64_tr_b16 v[210:211], v21 offset:20736
    v_fmac_f32 v249, v37, v244
    v_min_u32 v248, -2, v248
    v_min_u32 v249, -2, v249
    v_cmp_ne_u32 vcc, 1, v253
    v_mfma_f32_32x32x16_bf16 v[144:159], v[216:219], a[168:171], v[144:159]
    buffer_load_dwordx4 v8, s[40:43], s88 offen offset:3072 lds
    s_cbranch_vccnz L_dbg_slow
L_dbg_ok:
    s_waitcnt vmcnt(10) lgkmcnt(2)
    v_mfma_f32_32x32x16_bf16 v[128:143], v[220:223], a[60:63], v[128:143]
    ds_read_b64_tr_b16 v[212:213], v21 offset:21504
    ds_read_b64_tr_b16 v[214:215], v21 offset:21760
    buffer_store_dwordx2 v[248:249], v27, s[36:39], 0 offen sc1
    ds_read2_b32 v[250:251], v119 offset0:64 offset1:96
    v_mul_f32 v242, v46, v242
    s_add_u32 m0, s67, 8192
    s_add_u32 s82, s82, 256
    v_mfma_f32_32x32x16_bf16 v[144:159], v[220:223], a[172:175], v[144:159]
    buffer_load_dwordx4 v5, s[40:43], s82 offen lds
    v_mul_f32 v243, v46, v243
    v_fma_f32 v240, v44, v244, v242
    v_fma_f32 v241, v44, v245, v243
    v_fma_f32 v240, -v45, v245, v240
    s_waitcnt vmcnt(11) lgkmcnt(3)
    v_mfma_f32_32x32x16_bf16 v[128:143], v[208:211], a[64:67], v[128:143]
    ds_read_b64_tr_b16 v[216:217], v21 offset:22528
    ds_read_b64_tr_b16 v[218:219], v21 offset:22784
    v_fmac_f32 v241, v45, v244
    v_mul_f32 v50, v48, v240
    v_mul_f32 v51, v48, v241
    v_fma_f32 v50, -v49, v241, v50
    v_mfma_f32_32x32x16_bf16 v[144:159], v[208:211], a[176:179], v[144:159]
    buffer_load_dwordx4 v6, s[40:43], s82 offen offset:1024 lds
    v_fmac_f32 v51, v49, v240
    v_mul_f32 v96, v48, v64
    v_mul_f32 v97, v48, v80
    v_fma_f32 v96, -v49, v80, v96
    s_waitcnt vmcnt(11) lgkmcnt(3)
    v_mfma_f32_32x32x16_bf16 v[128:143], v[212:215], a[68:71], v[128:143]
    ds_read_b64_tr_b16 v[220:221], v21 offset:23552
    ds_read_b64_tr_b16 v[222:223], v21 offset:23808
    v_fmac_f32 v97, v49, v64
    v_mul_f32 v98, v48, v65
    v_mul_f32 v99, v48, v81
    v_fma_f32 v98, -v49, v81, v98
    v_mfma_f32_32x32x16_bf16 v[144:159], v[212:215], a[180:183], v[144:159]
    buffer_load_dwordx4 v7, s[40:43], s82 offen offset:2048 lds
    v_fmac_f32 v99, v49, v65
    v_mul_f32 v100, v48, v66
    v_mul_f32 v101, v48, v82
    v_fma_f32 v100, -v49, v82, v100
    s_waitcnt vmcnt(11) lgkmcnt(2)
    v_mfma_f32_32x32x16_bf16 v[128:143], v[216:219], a[72:75], v[128:143]
    ds_read_b64_tr_b16 v[208:209], v21 offset:0
    ds_read_b64_tr_b16 v[210:211], v21 offset:256
    buffer_load_dwordx4 v8, s[40:43], s82 offen offset:3072 lds
    v_fmac_f32 v101, v49, v66
    s_add_u32 m0, s67, 12288
    s_add_u32 s83, s83, 256
    v_mfma_f32_32x32x16_bf16 v[144:159], v[216:219], a[184:187], v[144:159]
    buffer_load_dwordx4 v5, s[40:43], s83 offen lds
    v_mul_f32 v102, v48, v67
    v_mul_f32 v103, v48, v83
    v_fma_f32 v102, -v49, v83, v102
    v_fmac_f32 v103, v49, v67
    s_waitcnt vmcnt(12) lgkmcnt(2)
    v_mfma_f32_32x32x16_bf16 v[128:143], v[220:223], a[76:79], v[128:143]
    ds_read_b64_tr_b16 v[212:213], v21 offset:1024
    ds_read_b64_tr_b16 v[214:215], v21 offset:1280
    v_mul_f32 v104, v48, v68
    v_mul_f32 v105, v48, v84
    v_fma_f32 v104, -v49, v84, v104
    v_fmac_f32 v105, v49, v68
    v_mfma_f32_32x32x16_bf16 v[144:159], v[220:223], a[188:191], v[144:159]
    buffer_load_dwordx4 v6, s[40:43], s83 offen offset:1024 lds
    v_mul_f32 v106, v48, v69
    v_mul_f32 v107, v48, v85
    v_fma_f32 v106, -v49, v85, v106
    v_fmac_f32 v107, v49, v69
    s_waitcnt vmcnt(12) lgkmcnt(2)
    v_mfma_f32_32x32x16_bf16 v[128:143], v[208:211], a[80:83], v[128:143]
    ds_read_b64_tr_b16 v[216:217], v21 offset:2048
    ds_read_b64_tr_b16 v[218:219], v21 offset:2304
    v_mul_f32 v108, v48, v70
    v_mul_f32 v109, v48, v86
    v_fma_f32 v108, -v49, v86, v108
    v_fmac_f32 v109, v49, v70
    v_mfma_f32_32x32x16_bf16 v[144:159], v[208:211], a[192:195], v[144:159]
    buffer_load_dwordx4 v7, s[40:43], s83 offen offset:2048 lds
    v_mul_f32 v110, v48, v71
    v_mul_f32 v111, v48, v87
    v_fma_f32 v110, -v49, v87, v110
    v_fmac_f32 v111, v49, v71
    s_waitcnt vmcnt(12) lgkmcnt(2)
    v_mfma_f32_32x32x16_bf16 v[128:143], v[212:215], a[84:87], v[128:143]
    ds_read_b64_tr_b16 v[220:221], v21 offset:3072
    ds_read_b64_tr_b16 v[222:223], v21 offset:3328
    v_mov_b32 v52, v250
    v_mov_b32 v54, v251
    v_mul_f32 v53, -2.0, v52
    v_mul_f32 v55, -2.0, v54
    v_mfma_f32_32x32x16_bf16 v[144:159], v[212:215], a[196:199], v[144:159]
    buffer_load_dwordx4 v8, s[40:43], s83 offen offset:3072 lds
    v_mul_f32 v112, v48, v72
    v_mul_f32 v113, v48, v88
    v_fma_f32 v112, -v49, v88, v112
    v_fmac_f32 v113, v49, v72
    s_waitcnt vmcnt(12) lgkmcnt(2)
    v_mfma_f32_32x32x16_bf16 v[128:143], v[216:219], a[88:91], v[128:143]
    ds_read_b64_tr_b16 v[208:209], v21 offset:4096
    ds_read_b64_tr_b16 v[210:211], v21 offset:4352
    v_mul_f32 v114, v48, v73
    v_mul_f32 v115, v48, v89
    s_add_u32 m0, s67, 16384
    s_add_u32 s84, s84, 256
    v_mfma_f32_32x32x16_bf16 v[144:159], v[216:219], a[200:203], v[144:159]
    buffer_load_dwordx4 v5, s[40:43], s84 offen lds
    v_fma_f32 v114, -v49, v89, v114
    v_fmac_f32 v115, v49, v73
    v_mul_f32 v116, v48, v74
    v_mul_f32 v117, v48, v90
    s_waitcnt vmcnt(12) lgkmcnt(2)
    v_mfma_f32_32x32x16_bf16 v[128:143], v[220:223], a[92:95], v[128:143]
    ds_read_b64_tr_b16 v[212:213], v21 offset:5120
    ds_read_b64_tr_b16 v[214:215], v21 offset:5376
    v_fma_f32 v116, -v49, v90, v116
    v_fmac_f32 v117, v49, v74
    v_mul_f32 v118, v48, v75
    v_mul_f32 v119, v48, v91
    v_mfma_f32_32x32x16_bf16 v[144:159], v[220:223], a[204:207], v[144:159]
    buffer_load_dwordx4 v6, s[40:43], s84 offen offset:1024 lds
    v_fma_f32 v118, -v49, v91, v118
    v_fmac_f32 v119, v49, v75
    v_mul_f32 v120, v48, v76
    v_mul_f32 v121, v48, v92
    s_waitcnt vmcnt(12) lgkmcnt(2)
    v_mfma_f32_32x32x16_bf16 v[128:143], v[208:211], a[96:99], v[128:143]
    ds_read_b64_tr_b16 v[216:217], v21 offset:6144
    ds_read_b64_tr_b16 v[218:219], v21 offset:6400
    v_fma_f32 v120, -v49, v92, v120
    v_fmac_f32 v121, v49, v76
    v_mul_f32 v122, v48, v77
    v_mul_f32 v123, v48, v93
    v_mfma_f32_32x32x16_bf16 v[144:159], v[208:211], a[208:211], v[144:159]
    buffer_load_dwordx4 v7, s[40:43], s84 offen offset:2048 lds
    v_fma_f32 v122, -v49, v93, v122
    v_fmac_f32 v123, v49, v77
    v_mul_f32 v124, v48, v78
    v_mul_f32 v125, v48, v94
    s_waitcnt vmcnt(12) lgkmcnt(2)
    v_mfma_f32_32x32x16_bf16 v[128:143], v[212:215], a[100:103], v[128:143]
    ds_read_b64_tr_b16 v[220:221], v21 offset:7168
    ds_read_b64_tr_b16 v[222:223], v21 offset:7424
    v_fma_f32 v124, -v49, v94, v124
    v_fmac_f32 v125, v49, v78
    v_mul_f32 v126, v48, v79
    v_mul_f32 v127, v48, v95
    v_mfma_f32_32x32x16_bf16 v[144:159], v[212:215], a[212:215], v[144:159]
    buffer_load_dwordx4 v8, s[40:43], s84 offen offset:3072 lds
    v_fma_f32 v126, -v49, v95, v126
    v_fmac_f32 v127, v49, v79
    s_waitcnt vmcnt(11) lgkmcnt(2)
    v_mfma_f32_32x32x16_bf16 v[128:143], v[216:219], a[104:107], v[128:143]
    ds_read_b64_tr_b16 v[208:209], v21 offset:8192
    ds_read_b64_tr_b16 v[210:211], v21 offset:8448
    s_add_u32 m0, s67, 20480
    s_add_u32 s85, s85, 256
    v_mfma_f32_32x32x16_bf16 v[144:159], v[216:219], a[216:219], v[144:159]
    buffer_load_dwordx4 v5, s[40:43], s85 offen lds
    s_waitcnt vmcnt(11) lgkmcnt(2)
    v_mfma_f32_32x32x16_bf16 v[128:143], v[220:223], a[108:111], v[128:143]
    ds_read_b64_tr_b16 v[212:213], v21 offset:9216
    ds_read_b64_tr_b16 v[214:215], v21 offset:9472
    v_mfma_f32_32x32x16_bf16 v[144:159], v[220:223], a[220:223], v[144:159]
    buffer_load_dwordx4 v6, s[40:43], s85 offen offset:1024 lds
    s_waitcnt vmcnt(11) lgkmcnt(2)
    v_mfma_f32_32x32x16_bf16 v[160:175], v[208:211], a[0:3], v[160:175]
    ds_read_b64_tr_b16 v[216:217], v21 offset:10240
    ds_read_b64_tr_b16 v[218:219], v21 offset:10496
    ds_read_b128 v[80:83], v254 offset:0
    v_and_b32 v62, 31, v0
    v_mul_u32_u24 v62, 896, v62
    v_lshrrev_b32 v63, 5, v0
    v_mfma_f32_32x32x16_bf16 v[176:191], v[208:211], a[112:115], v[176:191]
    buffer_load_dwordx4 v7, s[40:43], s85 offen offset:2048 lds
    ds_read_b128 v[84:87], v254 offset:32
    v_lshl_add_u32 v62, v63, 4, v62
    s_waitcnt vmcnt(11) lgkmcnt(4)
    v_mfma_f32_32x32x16_bf16 v[160:175], v[212:215], a[4:7], v[160:175]
    ds_read_b64_tr_b16 v[220:221], v21 offset:11264
    ds_read_b64_tr_b16 v[222:223], v21 offset:11520
    ds_read_b128 v[88:91], v254 offset:64
    v_mul_f32 v224, s72, v128
    v_exp_f32 v224, v224
    v_mul_f32 v225, s72, v129
    v_mfma_f32_32x32x16_bf16 v[176:191], v[212:215], a[116:119], v[176:191]
    buffer_load_dwordx4 v8, s[40:43], s85 offen offset:3072 lds
    ds_read_b128 v[92:95], v254 offset:96
    v_exp_f32 v225, v225
    v_mul_f32 v226, s72, v130
    s_add_u32 m0, s67, 0
    s_add_u32 s86, s86, 256
    s_waitcnt vmcnt(11) lgkmcnt(6)
    v_mfma_f32_32x32x16_bf16 v[160:175], v[216:219], a[8:11], v[160:175]
    ds_read_b64_tr_b16 v[208:209], v21 offset:12288
L_pg2:
    s_cbranch_execz L_warm
    ds_read_b64_tr_b16 v[210:211], v21 offset:12544
    buffer_load_dwordx4 v5, s[40:43], s86 offen lds
    v_exp_f32 v226, v226
    v_mul_f32 v227, s72, v131
    v_exp_f32 v227, v227
    v_mfma_f32_32x32x16_bf16 v[176:191], v[216:219], a[120:123], v[176:191]
    buffer_load_dwordx4 v6, s[40:43], s86 offen offset:1024 lds
    v_add_f32 v224, 1.0, v224
    v_add_f32 v225, 1.0, v225
    v_add_f32 v226, 1.0, v226
    v_add_f32 v227, 1.0, v227
    v_fma_f32 v224, v224, v224, 1.0
    s_waitcnt vmcnt(12) lgkmcnt(4)
    v_mfma_f32_32x32x16_bf16 v[160:175], v[220:223], a[12:15], v[160:175]
    ds_read_b64_tr_b16 v[212:213], v21 offset:13312
    ds_read_b64_tr_b16 v[214:215], v21 offset:13568
    v_rcp_f32 v224, v224
    v_fma_f32 v225, v225, v225, 1.0
    v_rcp_f32 v225, v225
    v_fma_f32 v226, v226, v226, 1.0
    v_mfma_f32_32x32x16_bf16 v[176:191], v[220:223], a[124:127], v[176:191]
    buffer_load_dwordx4 v7, s[40:43], s86 offen offset:2048 lds
    v_rcp_f32 v226, v226
    v_fma_f32 v227, v227, v227, 1.0
    v_rcp_f32 v227, v227
    v_fma_f32 v224, v53, v224, v52
    v_fma_f32 v225, v53, v225, v52
    s_waitcnt vmcnt(12) lgkmcnt(2)
    v_mfma_f32_32x32x16_bf16 v[160:175], v[208:211], a[16:19], v[160:175]
    ds_read_b64_tr_b16 v[216:217], v21 offset:14336
    ds_read_b64_tr_b16 v[218:219], v21 offset:14592
    v_fma_f32 v226, v53, v226, v52
    v_fma_f32 v227, v53, v227, v52
    v_mul_f32 v224, v128, v224
    v_mul_f32 v225, v129, v225
    v_mul_f32 v226, v130, v226
    v_mul_f32 v227, v131, v227
    v_mfma_f32_32x32x16_bf16 v[176:191], v[208:211], a[128:131], v[176:191]
    buffer_load_dwordx4 v8, s[40:43], s86 offen offset:3072 lds
    v_cvt_pk_bf16_f32 v128, v224, v225
    v_cvt_pk_bf16_f32 v129, v226, v227
    v_mul_f32 v228, s72, v132
    v_exp_f32 v228, v228
    v_mul_f32 v229, s72, v133
    s_waitcnt vmcnt(12) lgkmcnt(2)
    v_mfma_f32_32x32x16_bf16 v[160:175], v[212:215], a[20:23], v[160:175]
    ds_read_b64_tr_b16 v[220:221], v21 offset:15360
    ds_read_b64_tr_b16 v[222:223], v21 offset:15616
    v_exp_f32 v229, v229
    v_mul_f32 v230, s72, v134
    s_add_u32 m0, s67, 4096
    s_add_u32 s87, s87, 256
    v_mfma_f32_32x32x16_bf16 v[176:191], v[212:215], a[132:135], v[176:191]
    buffer_load_dwordx4 v5, s[40:43], s87 offen lds
    v_exp_f32 v230, v230
    v_mul_f32 v231, s72, v135
    v_exp_f32 v231, v231
    v_add_f32 v228, 1.0, v228
    v_add_f32 v229, 1.0, v229
    s_waitcnt vmcnt(12) lgkmcnt(2)
    v_mfma_f32_32x32x16_bf16 v[160:175], v[216:219], a[24:27], v[160:175]
    ds_read_b64_tr_b16 v[208:209], v21 offset:16384
    ds_read_b64_tr_b16 v[210:211], v21 offset:16640
    v_add_f32 v230, 1.0, v230
    v_add_f32 v231, 1.0, v231
    v_fma_f32 v228, v228, v228, 1.0
    v_rcp_f32 v228, v228
    v_fma_f32 v229, v229, v229, 1.0
    v_mfma_f32_32x32x16_bf16 v[176:191], v[216:219], a[136:139], v[176:191]
    buffer_load_dwordx4 v6, s[40:43], s87 offen offset:1024 lds
    v_rcp_f32 v229, v229
    v_fma_f32 v230, v230, v230, 1.0
    v_rcp_f32 v230, v230
    v_fma_f32 v231, v231, v231, 1.0
    s_waitcnt vmcnt(12) lgkmcnt(2)
    v_mfma_f32_32x32x16_bf16 v[160:175], v[220:223], a[28:31], v[160:175]
    ds_read_b64_tr_b16 v[212:213], v21 offset:17408
    ds_read_b64_tr_b16 v[214:215], v21 offset:17664
    buffer_load_dwordx4 v7, s[40:43], s87 offen offset:2048 lds
    v_rcp_f32 v231, v231
    v_fma_f32 v228, v53, v228, v52
    v_fma_f32 v229, v53, v229, v52
    v_fma_f32 v230, v53, v230, v52
    v_mfma_f32_32x32x16_bf16 v[176:191], v[220:223], a[140:143], v[176:191]
    buffer_load_dwordx4 v8, s[40:43], s87 offen offset:3072 lds
    v_fma_f32 v231, v53, v231, v52
    v_mul_f32 v228, v132, v228
    v_mul_f32 v229, v133, v229
    v_mul_f32 v230, v134, v230
    v_mul_f32 v231, v135, v231
    s_waitcnt vmcnt(13) lgkmcnt(2)
    v_mfma_f32_32x32x16_bf16 v[160:175], v[208:211], a[32:35], v[160:175]
    ds_read_b64_tr_b16 v[216:217], v21 offset:18432
    ds_read_b64_tr_b16 v[218:219], v21 offset:18688
    v_cvt_pk_bf16_f32 v130, v228, v229
    v_cvt_pk_bf16_f32 v131, v230, v231
    v_mul_f32 v224, s72, v136
    s_add_u32 m0, s67, 8192
    s_add_u32 s88, s88, 256
    v_mfma_f32_32x32x16_bf16 v[176:191], v[208:211], a[144:147], v[176:191]
    buffer_load_dwordx4 v5, s[40:43], s88 offen lds
    v_exp_f32 v224, v224
    v_mul_f32 v225, s72, v137
    v_exp_f32 v225, v225
    v_mul_f32 v226, s72, v138
    s_waitcnt vmcnt(13) lgkmcnt(2)
    v_mfma_f32_32x32x16_bf16 v[160:175], v[212:215], a[36:39], v[160:175]
    ds_read_b64_tr_b16 v[220:221], v21 offset:19456
    ds_read_b64_tr_b16 v[222:223], v21 offset:19712
    v_exp_f32 v226, v226
    v_mul_f32 v227, s72, v139
    v_exp_f32 v227, v227
    v_add_f32 v224, 1.0, v224
    v_add_f32 v225, 1.0, v225
    v_mfma_f32_32x32x16_bf16 v[176:191], v[212:215], a[148:151], v[176:191]
    buffer_load_dwordx4 v6, s[40:43], s88 offen offset:1024 lds
    v_add_f32 v226, 1.0, v226
    v_add_f32 v227, 1.0, v227
    v_fma_f32 v224, v224, v224, 1.0
    v_rcp_f32 v224, v224
    v_fma_f32 v225, v225, v225, 1.0
    s_waitcnt vmcnt(13) lgkmcnt(2)
    v_mfma_f32_32x32x16_bf16 v[160:175], v[216:219], a[40:43], v[160:175]
    ds_read_b64_tr_b16 v[208:209], v21 offset:20480
    ds_read_b64_tr_b16 v[210:211], v21 offset:20736
    v_rcp_f32 v225, v225
    v_fma_f32 v226, v226, v226, 1.0
    v_rcp_f32 v226, v226
    v_fma_f32 v227, v227, v227, 1.0
    v_mfma_f32_32x32x16_bf16 v[176:191], v[216:219], a[152:155], v[176:191]
    buffer_load_dwordx4 v7, s[40:43], s88 offen offset:2048 lds
    v_rcp_f32 v227, v227
    v_fma_f32 v224, v53, v224, v52
    v_fma_f32 v225, v53, v225, v52
    v_fma_f32 v226, v53, v226, v52
    v_fma_f32 v227, v53, v227, v52
    s_waitcnt vmcnt(13) lgkmcnt(2)
    v_mfma_f32_32x32x16_bf16 v[160:175], v[220:223], a[44:47], v[160:175]
    ds_read_b64_tr_b16 v[212:213], v21 offset:21504
    ds_read_b64_tr_b16 v[214:215], v21 offset:21760
    v_mul_f32 v224, v136, v224
    v_mul_f32 v225, v137, v225
    v_mul_f32 v226, v138, v226
    v_mul_f32 v227, v139, v227
    v_cvt_pk_bf16_f32 v136, v224, v225
    v_cvt_pk_bf16_f32 v137, v226, v227
    v_mfma_f32_32x32x16_bf16 v[176:191], v[220:223], a[156:159], v[176:191]
    buffer_load_dwordx4 v8, s[40:43], s88 offen offset:3072 lds
    v_mul_f32 v228, s72, v140
    v_exp_f32 v228, v228
    v_mul_f32 v229, s72, v141
    v_exp_f32 v229, v229
    s_waitcnt vmcnt(13) lgkmcnt(2)
    v_mfma_f32_32x32x16_bf16 v[160:175], v[208:211], a[48:51], v[160:175]
    ds_read_b64_tr_b16 v[216:217], v21 offset:22528
    ds_read_b64_tr_b16 v[218:219], v21 offset:22784
    v_mul_f32 v230, s72, v142
    v_exp_f32 v230, v230
    v_mul_f32 v231, s72, v143
    s_add_u32 m0, s67, 12288
    v_mfma_f32_32x32x16_bf16 v[176:191], v[208:211], a[160:163], v[176:191]
    buffer_load_dwordx4 v9, s[44:47], s4 offen lds
    v_exp_f32 v231, v231
    v_add_f32 v228, 1.0, v228
    v_add_f32 v229, 1.0, v229
    v_add_f32 v230, 1.0, v230
    v_add_f32 v231, 1.0, v231
    v_fma_f32 v228, v228, v228, 1.0
    s_waitcnt vmcnt(13) lgkmcnt(2)
    v_mfma_f32_32x32x16_bf16 v[160:175], v[212:215], a[52:55], v[160:175]
    ds_read_b64_tr_b16 v[220:221], v21 offset:23552
    ds_read_b64_tr_b16 v[222:223], v21 offset:23808
    buffer_load_dwordx4 v10, s[44:47], s4 offen offset:1024 lds
    v_rcp_f32 v228, v228
    v_fma_f32 v229, v229, v229, 1.0
    v_rcp_f32 v229, v229
    v_mfma_f32_32x32x16_bf16 v[176:191], v[212:215], a[164:167], v[176:191]
    buffer_load_dwordx4 v11, s[44:47], s4 offen offset:2048 lds
    v_fma_f32 v230, v230, v230, 1.0
    v_rcp_f32 v230, v230
    v_fma_f32 v231, v231, v231, 1.0
    v_rcp_f32 v231, v231
    s_waitcnt vmcnt(14) lgkmcnt(2)
    v_mfma_f32_32x32x16_bf16 v[160:175], v[216:219], a[56:59], v[160:175]
    ds_read_b64_tr_b16 v[208:209], v21 offset:0
    ds_read_b64_tr_b16 v[210:211], v21 offset:256
    v_fma_f32 v228, v53, v228, v52
    v_fma_f32 v229, v53, v229, v52
    v_fma_f32 v230, v53, v230, v52
    v_fma_f32 v231, v53, v231, v52
    v_mul_f32 v228, v140, v228
    v_mul_f32 v229, v141, v229
    v_mfma_f32_32x32x16_bf16 v[176:191], v[216:219], a[168:171], v[176:191]
    buffer_load_dwordx4 v12, s[44:47], s4 offen offset:3072 lds
    v_mul_f32 v230, v142, v230
    v_mul_f32 v231, v143, v231
    v_cvt_pk_bf16_f32 v138, v228, v229
    v_cvt_pk_bf16_f32 v139, v230, v231
    v_mul_f32 v224, s72, v144
    s_waitcnt vmcnt(14) lgkmcnt(2)
    v_mfma_f32_32x32x16_bf16 v[160:175], v[220:223], a[60:63], v[160:175]
    ds_read_b64_tr_b16 v[212:213], v21 offset:1024
    ds_read_b64_tr_b16 v[214:215], v21 offset:1280
    v_exp_f32 v224, v224
    v_mul_f32 v225, s72, v145
    s_add_u32 m0, s67, 16384
    s_add_u32 s68, s4, 57344
    v_mfma_f32_32x32x16_bf16 v[176:191], v[220:223], a[172:175], v[176:191]
    buffer_load_dwordx4 v9, s[44:47], s68 offen lds
    v_exp_f32 v225, v225
    v_mul_f32 v226, s72, v146
    v_exp_f32 v226, v226
    v_mul_f32 v227, s72, v147
    s_waitcnt vmcnt(14) lgkmcnt(2)
    v_mfma_f32_32x32x16_bf16 v[160:175], v[208:211], a[64:67], v[160:175]
    ds_read_b64_tr_b16 v[216:217], v21 offset:2048
    ds_read_b64_tr_b16 v[218:219], v21 offset:2304
    v_exp_f32 v227, v227
    v_add_f32 v224, 1.0, v224
    v_add_f32 v225, 1.0, v225
    v_add_f32 v226, 1.0, v226
    v_add_f32 v227, 1.0, v227
    v_fma_f32 v224, v224, v224, 1.0
    v_mfma_f32_32x32x16_bf16 v[176:191], v[208:211], a[176:179], v[176:191]
    buffer_load_dwordx4 v10, s[44:47], s68 offen offset:1024 lds
    v_rcp_f32 v224, v224
    v_fma_f32 v225, v225, v225, 1.0
    v_rcp_f32 v225, v225
    v_fma_f32 v226, v226, v226, 1.0
    s_waitcnt vmcnt(14) lgkmcnt(2)
    v_mfma_f32_32x32x16_bf16 v[160:175], v[212:215], a[68:71], v[160:175]
    ds_read_b64_tr_b16 v[220:221], v21 offset:3072
    ds_read_b64_tr_b16 v[222:223], v21 offset:3328
    v_rcp_f32 v226, v226
    v_fma_f32 v227, v227, v227, 1.0
    v_rcp_f32 v227, v227
    v_fma_f32 v224, v55, v224, v54
    v_mfma_f32_32x32x16_bf16 v[176:191], v[212:215], a[180:183], v[176:191]
    buffer_load_dwordx4 v11, s[44:47], s68 offen offset:2048 lds
    v_fma_f32 v225, v55, v225, v54
    v_fma_f32 v226, v55, v226, v54
    v_fma_f32 v227, v55, v227, v54
    v_mul_f32 v224, v144, v224
    v_mul_f32 v225, v145, v225
    v_mul_f32 v226, v146, v226
    s_waitcnt vmcnt(14) lgkmcnt(2)
    v_mfma_f32_32x32x16_bf16 v[160:175], v[216:219], a[72:75], v[160:175]
    ds_read_b64_tr_b16 v[208:209], v21 offset:4096
    ds_read_b64_tr_b16 v[210:211], v21 offset:4352
    buffer_load_dwordx4 v12, s[44:47], s68 offen offset:3072 lds
    v_mul_f32 v227, v147, v227
    v_cvt_pk_bf16_f32 v144, v224, v225
    v_cvt_pk_bf16_f32 v145, v226, v227
    v_mul_f32 v228, s72, v148
    s_add_u32 m0, s67, 20480
    v_mfma_f32_32x32x16_bf16 v[176:191], v[216:219], a[184:187], v[176:191]
    buffer_load_dwordx4 v1, s[12:15], s11 offen lds
    v_exp_f32 v228, v228
    v_mul_f32 v229, s72, v149
    v_exp_f32 v229, v229
    v_mul_f32 v230, s72, v150
    s_waitcnt vmcnt(15) lgkmcnt(2)
    v_mfma_f32_32x32x16_bf16 v[160:175], v[220:223], a[76:79], v[160:175]
    ds_read_b64_tr_b16 v[212:213], v21 offset:5120
    ds_read_b64_tr_b16 v[214:215], v21 offset:5376
    v_exp_f32 v230, v230
    v_mul_f32 v231, s72, v151
    v_exp_f32 v231, v231
    v_add_f32 v228, 1.0, v228
    v_mfma_f32_32x32x16_bf16 v[176:191], v[220:223], a[188:191], v[176:191]
    buffer_load_dwordx4 v2, s[12:15], s11 offen offset:1024 lds
    v_add_f32 v229, 1.0, v229
    v_add_f32 v230, 1.0, v230
    v_add_f32 v231, 1.0, v231
    v_fma_f32 v228, v228, v228, 1.0
    v_rcp_f32 v228, v228
    s_waitcnt vmcnt(15) lgkmcnt(2)
    v_mfma_f32_32x32x16_bf16 v[160:175], v[208:211], a[80:83], v[160:175]
    ds_read_b64_tr_b16 v[216:217], v21 offset:6144
    ds_read_b64_tr_b16 v[218:219], v21 offset:6400
    v_fma_f32 v229, v229, v229, 1.0
    v_rcp_f32 v229, v229
    v_fma_f32 v230, v230, v230, 1.0
    v_rcp_f32 v230, v230
    v_mfma_f32_32x32x16_bf16 v[176:191], v[208:211], a[192:195], v[176:191]
    buffer_load_dwordx4 v3, s[12:15], s11 offen offset:2048 lds
    v_fma_f32 v231, v231, v231, 1.0
    v_rcp_f32 v231, v231
    v_fma_f32 v228, v55, v228, v54
    v_fma_f32 v229, v55, v229, v54
    v_fma_f32 v230, v55, v230, v54
    s_waitcnt vmcnt(15) lgkmcnt(2)
    v_mfma_f32_32x32x16_bf16 v[160:175], v[212:215], a[84:87], v[160:175]
    ds_read_b64_tr_b16 v[220:221], v21 offset:7168
    ds_read_b64_tr_b16 v[222:223], v21 offset:7424
    v_fma_f32 v231, v55, v231, v54
    v_mul_f32 v228, v148, v228
    v_mul_f32 v229, v149, v229
    v_mul_f32 v230, v150, v230
    v_mul_f32 v231, v151, v231
    v_mfma_f32_32x32x16_bf16 v[176:191], v[212:215], a[196:199], v[176:191]
    buffer_load_dwordx4 v4, s[12:15], s11 offen offset:3072 lds
    v_cvt_pk_bf16_f32 v146, v228, v229
    v_cvt_pk_bf16_f32 v147, v230, v231
    v_mul_f32 v224, s72, v152
    v_exp_f32 v224, v224
    v_mul_f32 v225, s72, v153
    s_waitcnt vmcnt(15) lgkmcnt(2)
    v_mfma_f32_32x32x16_bf16 v[160:175], v[216:219], a[88:91], v[160:175]
    ds_read_b64_tr_b16 v[208:209], v21 offset:8192
    ds_read_b64_tr_b16 v[210:211], v21 offset:8448
    v_exp_f32 v225, v225
    v_mul_f32 v226, s72, v154
    v_exp_f32 v226, v226
    s_add_u32 m0, s67, 0
    v_mfma_f32_32x32x16_bf16 v[176:191], v[216:219], a[200:203], v[176:191]
    buffer_load_dwordx4 v9, s[44:47], s8 offen lds
    v_mul_f32 v227, s72, v155
    v_exp_f32 v227, v227
    v_add_f32 v224, 1.0, v224
    v_add_f32 v225, 1.0, v225
    v_add_f32 v226, 1.0, v226
    s_waitcnt vmcnt(15) lgkmcnt(2)
    v_mfma_f32_32x32x16_bf16 v[160:175], v[220:223], a[92:95], v[160:175]
    ds_read_b64_tr_b16 v[212:213], v21 offset:9216
    ds_read_b64_tr_b16 v[214:215], v21 offset:9472
    v_add_f32 v227, 1.0, v227
    v_fma_f32 v224, v224, v224, 1.0
    v_rcp_f32 v224, v224
    v_fma_f32 v225, v225, v225, 1.0
    v_mfma_f32_32x32x16_bf16 v[176:191], v[220:223], a[204:207], v[176:191]
    buffer_load_dwordx4 v10, s[44:47], s8 offen offset:1024 lds
    v_rcp_f32 v225, v225
    v_fma_f32 v226, v226, v226, 1.0
    v_rcp_f32 v226, v226
    v_fma_f32 v227, v227, v227, 1.0
    s_waitcnt vmcnt(15) lgkmcnt(2)
    v_mfma_f32_32x32x16_bf16 v[160:175], v[208:211], a[96:99], v[160:175]
    ds_read_b64_tr_b16 v[216:217], v21 offset:10240
    ds_read_b64_tr_b16 v[218:219], v21 offset:10496
    buffer_load_dwordx4 v11, s[44:47], s8 offen offset:2048 lds
    v_rcp_f32 v227, v227
    v_fma_f32 v224, v55, v224, v54
    v_fma_f32 v225, v55, v225, v54
    v_fma_f32 v226, v55, v226, v54
    v_fma_f32 v227, v55, v227, v54
    v_mfma_f32_32x32x16_bf16 v[176:191], v[208:211], a[208:211], v[176:191]
    buffer_load_dwordx4 v12, s[44:47], s8 offen offset:3072 lds
    v_mul_f32 v224, v152, v224
    v_mul_f32 v225, v153, v225
    v_mul_f32 v226, v154, v226
    v_mul_f32 v227, v155, v227
    v_cvt_pk_bf16_f32 v152, v224, v225
    v_cvt_pk_bf16_f32 v153, v226, v227
    s_waitcnt vmcnt(16) lgkmcnt(2)
    v_mfma_f32_32x32x16_bf16 v[160:175], v[212:215], a[100:103], v[160:175]
    ds_read_b64_tr_b16 v[220:221], v21 offset:11264
    ds_read_b64_tr_b16 v[222:223], v21 offset:11520
    v_mul_f32 v228, s72, v156
    v_exp_f32 v228, v228
    v_mul_f32 v229, s72, v157
    s_add_u32 m0, s67, 4096
    s_add_u32 s68, s8, 57344
    v_mfma_f32_32x32x16_bf16 v[176:191], v[212:215], a[212:215], v[176:191]
    buffer_load_dwordx4 v9, s[44:47], s68 offen lds
    v_exp_f32 v229, v229
    v_mul_f32 v230, s72, v158
    v_exp_f32 v230, v230
    v_mul_f32 v231, s72, v159
    s_waitcnt lgkmcnt(2)
    v_mfma_f32_32x32x16_bf16 v[160:175], v[216:219], a[104:107], v[160:175]
    v_exp_f32 v231, v231
    v_add_f32 v228, 1.0, v228
    v_add_f32 v229, 1.0, v229
    v_add_f32 v230, 1.0, v230
    v_add_f32 v231, 1.0, v231
    v_fma_f32 v228, v228, v228, 1.0
    v_mfma_f32_32x32x16_bf16 v[176:191], v[216:219], a[216:219], v[176:191]
    buffer_load_dwordx4 v10, s[44:47], s68 offen offset:1024 lds
    v_rcp_f32 v228, v228
    v_fma_f32 v229, v229, v229, 1.0
    v_rcp_f32 v229, v229
    v_fma_f32 v230, v230, v230, 1.0
    s_waitcnt lgkmcnt(0)
    v_mfma_f32_32x32x16_bf16 v[160:175], v[220:223], a[108:111], v[160:175]
    v_rcp_f32 v230, v230
    v_fma_f32 v231, v231, v231, 1.0
    v_rcp_f32 v231, v231
    v_fma_f32 v228, v55, v228, v54
    v_fma_f32 v229, v55, v229, v54
    v_fma_f32 v230, v55, v230, v54
    v_fma_f32 v231, v55, v231, v54
    v_mfma_f32_32x32x16_bf16 v[176:191], v[220:223], a[220:223], v[176:191]
    buffer_load_dwordx4 v11, s[44:47], s68 offen offset:2048 lds
    v_mul_f32 v228, v156, v228
    v_mul_f32 v229, v157, v229
    v_mul_f32 v230, v158, v230
    v_mul_f32 v231, v159, v231
    v_cvt_pk_bf16_f32 v154, v228, v229
    v_cvt_pk_bf16_f32 v155, v230, v231
    buffer_load_dwordx2 v[64:65], v26, s[36:39], 0 offen offset:0 sc1
    v_pk_mul_f32 v[224:225], s[72:73], v[160:161]
    v_pk_mul_f32 v[226:227], s[72:73], v[162:163]
    v_exp_f32 v224, v224
    v_exp_f32 v225, v225
    v_exp_f32 v226, v226
    v_exp_f32 v227, v227
    buffer_load_dwordx2 v[66:67], v26, s[36:39], 0 offen offset:128 sc1
    v_pk_add_f32 v[224:225], s[74:75], v[224:225]
    v_pk_add_f32 v[226:227], s[74:75], v[226:227]
    v_pk_fma_f32 v[224:225], v[224:225], v[224:225], s[74:75]
    v_pk_fma_f32 v[226:227], v[226:227], v[226:227], s[74:75]
    v_rcp_f32 v224, v224
    v_rcp_f32 v225, v225
    buffer_load_dwordx2 v[68:69], v26, s[36:39], 0 offen offset:256 sc1
    v_rcp_f32 v226, v226
    v_rcp_f32 v227, v227
    v_pk_fma_f32 v[224:225], v[52:53], v[224:225], v[52:53] op_sel:[1,0,0] op_sel_hi:[1,1,0]
    v_pk_fma_f32 v[226:227], v[52:53], v[226:227], v[52:53] op_sel:[1,0,0] op_sel_hi:[1,1,0]
    v_pk_mul_f32 v[224:225], v[160:161], v[224:225]
    v_pk_mul_f32 v[226:227], v[162:163], v[226:227]
    v_cvt_pk_bf16_f32 v160, v224, v225
    buffer_load_dwordx2 v[70:71], v26, s[36:39], 0 offen offset:384 sc1
    v_cvt_pk_bf16_f32 v161, v226, v227
    v_pk_mul_f32 v[228:229], s[72:73], v[164:165]
    v_pk_mul_f32 v[230:231], s[72:73], v[166:167]
    v_exp_f32 v228, v228
    v_exp_f32 v229, v229
    v_exp_f32 v230, v230
    buffer_load_dwordx2 v[72:73], v26, s[36:39], 0 offen offset:512 sc1
    v_exp_f32 v231, v231
    v_pk_add_f32 v[228:229], s[74:75], v[228:229]
    v_pk_add_f32 v[230:231], s[74:75], v[230:231]
    v_pk_fma_f32 v[228:229], v[228:229], v[228:229], s[74:75]
    v_pk_fma_f32 v[230:231], v[230:231], v[230:231], s[74:75]
    v_rcp_f32 v228, v228
    v_rcp_f32 v229, v229
    buffer_load_dwordx2 v[74:75], v26, s[36:39], 0 offen offset:640 sc1
    v_rcp_f32 v230, v230
    v_rcp_f32 v231, v231
    v_pk_fma_f32 v[228:229], v[52:53], v[228:229], v[52:53] op_sel:[1,0,0] op_sel_hi:[1,1,0]
    v_pk_fma_f32 v[230:231], v[52:53], v[230:231], v[52:53] op_sel:[1,0,0] op_sel_hi:[1,1,0]
    v_pk_mul_f32 v[228:229], v[164:165], v[228:229]
    v_pk_mul_f32 v[230:231], v[166:167], v[230:231]
    buffer_load_dwordx2 v[76:77], v26, s[36:39], 0 offen offset:768 sc1
    v_cvt_pk_bf16_f32 v162, v228, v229
    v_cvt_pk_bf16_f32 v163, v230, v231
    v_pk_mul_f32 v[224:225], s[72:73], v[168:169]
    v_pk_mul_f32 v[226:227], s[72:73], v[170:171]
    v_exp_f32 v224, v224
    v_exp_f32 v225, v225
    v_exp_f32 v226, v226
    buffer_load_dwordx2 v[78:79], v26, s[36:39], 0 offen offset:896 sc1
    v_exp_f32 v227, v227
    v_pk_add_f32 v[224:225], s[74:75], v[224:225]
    v_pk_add_f32 v[226:227], s[74:75], v[226:227]
    v_pk_fma_f32 v[224:225], v[224:225], v[224:225], s[74:75]
    v_pk_fma_f32 v[226:227], v[226:227], v[226:227], s[74:75]
    v_rcp_f32 v224, v224
    buffer_load_dwordx4 v12, s[44:47], s68 offen offset:3072 lds
    v_rcp_f32 v225, v225
    v_rcp_f32 v226, v226
    v_rcp_f32 v227, v227
    v_pk_fma_f32 v[224:225], v[52:53], v[224:225], v[52:53] op_sel:[1,0,0] op_sel_hi:[1,1,0]
    v_pk_fma_f32 v[226:227], v[52:53], v[226:227], v[52:53] op_sel:[1,0,0] op_sel_hi:[1,1,0]
    v_pk_mul_f32 v[224:225], v[168:169], v[224:225]
    s_add_u32 m0, s67, 8192
    s_nop 0
    buffer_load_dwordx4 v1, s[16:19], s11 offen lds
    v_pk_mul_f32 v[226:227], v[170:171], v[226:227]
    v_cvt_pk_bf16_f32 v168, v224, v225
    v_cvt_pk_bf16_f32 v169, v226, v227
    v_pk_mul_f32 v[228:229], s[72:73], v[172:173]
    v_pk_mul_f32 v[230:231], s[72:73], v[174:175]
    v_exp_f32 v228, v228
    v_exp_f32 v229, v229
    v_exp_f32 v230, v230
    v_exp_f32 v231, v231
    v_pk_add_f32 v[228:229], s[74:75], v[228:229]
    v_pk_add_f32 v[230:231], s[74:75], v[230:231]
    v_pk_fma_f32 v[228:229], v[228:229], v[228:229], s[74:75]
    v_pk_fma_f32 v[230:231], v[230:231], v[230:231], s[74:75]
    v_rcp_f32 v228, v228
    v_rcp_f32 v229, v229
    v_rcp_f32 v230, v230
    v_rcp_f32 v231, v231
    v_pk_fma_f32 v[228:229], v[52:53], v[228:229], v[52:53] op_sel:[1,0,0] op_sel_hi:[1,1,0]
    v_pk_fma_f32 v[230:231], v[52:53], v[230:231], v[52:53] op_sel:[1,0,0] op_sel_hi:[1,1,0]
    v_pk_mul_f32 v[228:229], v[172:173], v[228:229]
    v_pk_mul_f32 v[230:231], v[174:175], v[230:231]
    v_cvt_pk_bf16_f32 v170, v228, v229
    v_cvt_pk_bf16_f32 v171, v230, v231
    v_pk_mul_f32 v[224:225], s[72:73], v[176:177]
    v_pk_mul_f32 v[226:227], s[72:73], v[178:179]
    v_exp_f32 v224, v224
    v_exp_f32 v225, v225
    v_exp_f32 v226, v226
    v_exp_f32 v227, v227
    v_pk_add_f32 v[224:225], s[74:75], v[224:225]
    v_pk_add_f32 v[226:227], s[74:75], v[226:227]
    v_pk_fma_f32 v[224:225], v[224:225], v[224:225], s[74:75]
    v_pk_fma_f32 v[226:227], v[226:227], v[226:227], s[74:75]
    v_rcp_f32 v224, v224
    v_rcp_f32 v225, v225
    v_rcp_f32 v226, v226
    v_rcp_f32 v227, v227
    v_pk_fma_f32 v[224:225], v[54:55], v[224:225], v[54:55] op_sel:[1,0,0] op_sel_hi:[1,1,0]
    v_pk_fma_f32 v[226:227], v[54:55], v[226:227], v[54:55] op_sel:[1,0,0] op_sel_hi:[1,1,0]
    v_pk_mul_f32 v[224:225], v[176:177], v[224:225]
    v_pk_mul_f32 v[226:227], v[178:179], v[226:227]
    v_cvt_pk_bf16_f32 v176, v224, v225
    v_cvt_pk_bf16_f32 v177, v226, v227
    v_pk_mul_f32 v[228:229], s[72:73], v[180:181]
    v_pk_mul_f32 v[230:231], s[72:73], v[182:183]
    v_exp_f32 v228, v228
    v_exp_f32 v229, v229
    v_exp_f32 v230, v230
    v_exp_f32 v231, v231
    v_pk_add_f32 v[228:229], s[74:75], v[228:229]
    v_pk_add_f32 v[230:231], s[74:75], v[230:231]
    v_pk_fma_f32 v[228:229], v[228:229], v[228:229], s[74:75]
    v_pk_fma_f32 v[230:231], v[230:231], v[230:231], s[74:75]
    v_rcp_f32 v228, v228
    v_rcp_f32 v229, v229
    ds_write_b128 v29, v[128:131] offset:0
    v_rcp_f32 v230, v230
    v_rcp_f32 v231, v231
    v_pk_fma_f32 v[228:229], v[54:55], v[228:229], v[54:55] op_sel:[1,0,0] op_sel_hi:[1,1,0]
    v_pk_fma_f32 v[230:231], v[54:55], v[230:231], v[54:55] op_sel:[1,0,0] op_sel_hi:[1,1,0]
    v_pk_mul_f32 v[228:229], v[180:181], v[228:229]
    v_pk_mul_f32 v[230:231], v[182:183], v[230:231]
    v_cvt_pk_bf16_f32 v178, v228, v229
    v_cvt_pk_bf16_f32 v179, v230, v231
    v_pk_mul_f32 v[224:225], s[72:73], v[184:185]
    v_pk_mul_f32 v[226:227], s[72:73], v[186:187]
    v_exp_f32 v224, v224
    v_exp_f32 v225, v225
    v_exp_f32 v226, v226
    v_exp_f32 v227, v227
    v_pk_add_f32 v[224:225], s[74:75], v[224:225]
    ds_write_b128 v29, v[136:139] offset:2048
    v_pk_add_f32 v[226:227], s[74:75], v[226:227]
    v_pk_fma_f32 v[224:225], v[224:225], v[224:225], s[74:75]
    v_pk_fma_f32 v[226:227], v[226:227], v[226:227], s[74:75]
    v_rcp_f32 v224, v224
    v_rcp_f32 v225, v225
    v_rcp_f32 v226, v226
    v_rcp_f32 v227, v227
    v_pk_fma_f32 v[224:225], v[54:55], v[224:225], v[54:55] op_sel:[1,0,0] op_sel_hi:[1,1,0]
    v_pk_fma_f32 v[226:227], v[54:55], v[226:227], v[54:55] op_sel:[1,0,0] op_sel_hi:[1,1,0]
    v_pk_mul_f32 v[224:225], v[184:185], v[224:225]
    v_pk_mul_f32 v[226:227], v[186:187], v[226:227]
    v_cvt_pk_bf16_f32 v184, v224, v225
    v_cvt_pk_bf16_f32 v185, v226, v227
    v_pk_mul_f32 v[228:229], s[72:73], v[188:189]
    v_pk_mul_f32 v[230:231], s[72:73], v[190:191]
    v_exp_f32 v228, v228
    ds_write_b128 v29, v[144:147] offset:1024
    v_exp_f32 v229, v229
    v_exp_f32 v230, v230
    v_exp_f32 v231, v231
    v_pk_add_f32 v[228:229], s[74:75], v[228:229]
    v_pk_add_f32 v[230:231], s[74:75], v[230:231]
    v_pk_fma_f32 v[228:229], v[228:229], v[228:229], s[74:75]
    v_pk_fma_f32 v[230:231], v[230:231], v[230:231], s[74:75]
    v_rcp_f32 v228, v228
    v_rcp_f32 v229, v229
    v_rcp_f32 v230, v230
    v_rcp_f32 v231, v231
    v_pk_fma_f32 v[228:229], v[54:55], v[228:229], v[54:55] op_sel:[1,0,0] op_sel_hi:[1,1,0]
    buffer_load_dwordx4 a[192:195], v62, s[12:15], s60 offen offset:0
    v_pk_fma_f32 v[230:231], v[54:55], v[230:231], v[54:55] op_sel:[1,0,0] op_sel_hi:[1,1,0]
    ds_write_b128 v29, v[152:155] offset:3072
    v_pk_mul_f32 v[228:229], v[188:189], v[228:229]
    v_pk_mul_f32 v[230:231], v[190:191], v[230:231]
    v_cvt_pk_bf16_f32 v186, v228, v229
    v_cvt_pk_bf16_f32 v187, v230, v231
    s_waitcnt vmcnt(3)
    v_max3_u32 v224, v64, v65, v66
    v_max3_u32 v225, v67, v68, v69
    v_max3_u32 v224, v224, v70, v71
    v_max3_u32 v225, v225, v72, v73
    v_max3_u32 v224, v224, v74, v75
    v_max3_u32 v225, v225, v76, v77
    v_max3_u32 v224, v224, v78, v79
    v_max_u32 v224, v224, v225
    v_cmp_eq_u32 vcc, -1, v224
    s_nop 0
    s_cbranch_vccnz L_st_slow
L_st_ok:
    v_pk_fma_f32 v[76:77], v[38:39], v[78:79], v[76:77] op_sel:[0,0,0] op_sel_hi:[0,1,1]
    v_pk_fma_f32 v[76:77], v[38:39], v[78:79], v[76:77] op_sel:[1,1,0] op_sel_hi:[1,0,1] neg_lo:[1,0,0]
    v_pk_fma_f32 v[74:75], v[38:39], v[76:77], v[74:75] op_sel:[0,0,0] op_sel_hi:[0,1,1]
    v_pk_fma_f32 v[74:75], v[38:39], v[76:77], v[74:75] op_sel:[1,1,0] op_sel_hi:[1,0,1] neg_lo:[1,0,0]
    v_pk_fma_f32 v[72:73], v[38:39], v[74:75], v[72:73] op_sel:[0,0,0] op_sel_hi:[0,1,1]
    v_pk_fma_f32 v[72:73], v[38:39], v[74:75], v[72:73] op_sel:[1,1,0] op_sel_hi:[1,0,1] neg_lo:[1,0,0]
    ds_write_b128 v29, v[160:163] offset:16384
    v_pk_fma_f32 v[70:71], v[38:39], v[72:73], v[70:71] op_sel:[0,0,0] op_sel_hi:[0,1,1]
    v_pk_fma_f32 v[70:71], v[38:39], v[72:73], v[70:71] op_sel:[1,1,0] op_sel_hi:[1,0,1] neg_lo:[1,0,0]
    v_pk_fma_f32 v[68:69], v[38:39], v[70:71], v[68:69] op_sel:[0,0,0] op_sel_hi:[0,1,1]
    v_pk_fma_f32 v[68:69], v[38:39], v[70:71], v[68:69] op_sel:[1,1,0] op_sel_hi:[1,0,1] neg_lo:[1,0,0]
    buffer_load_dwordx4 a[196:199], v62, s[12:15], s60 offen offset:32
    v_pk_fma_f32 v[66:67], v[38:39], v[68:69], v[66:67] op_sel:[0,0,0] op_sel_hi:[0,1,1]
    v_pk_fma_f32 v[66:67], v[38:39], v[68:69], v[66:67] op_sel:[1,1,0] op_sel_hi:[1,0,1] neg_lo:[1,0,0]
    v_pk_fma_f32 v[64:65], v[38:39], v[66:67], v[64:65] op_sel:[0,0,0] op_sel_hi:[0,1,1]
    v_pk_fma_f32 v[64:65], v[38:39], v[66:67], v[64:65] op_sel:[1,1,0] op_sel_hi:[1,0,1] neg_lo:[1,0,0]
    v_pk_mul_f32 v[224:225], v[40:41], v[64:65] op_sel:[0,0] op_sel_hi:[0,1]
    v_pk_fma_f32 v[224:225], v[40:41], v[64:65], v[224:225] op_sel:[1,1,0] op_sel_hi:[1,0,1] neg_lo:[1,0,0]
    v_mov_b32 v226, v224
    v_mov_b32 v227, v225
    s_nop 0
    v_permlane32_swap_b32 v224, v226
    v_permlane32_swap_b32 v225, v227
    v_pk_add_f32 v[224:225], v[224:225], v[226:227]
    v_mov_b32 v226, v224
    v_mov_b32 v227, v225
    s_nop 0
    v_permlane16_swap_b32 v224, v226
    ds_write_b128 v29, v[168:171] offset:18432
    v_permlane16_swap_b32 v225, v227
    v_pk_add_f32 v[224:225], v[224:225], v[226:227]
    v_pk_fma_f32 v[226:227], v[42:43], v[224:225], v[50:51] op_sel:[0,0,0] op_sel_hi:[0,1,1]
    v_pk_fma_f32 v[226:227], v[42:43], v[224:225], v[226:227] op_sel:[1,1,0] op_sel_hi:[1,0,1] neg_lo:[1,0,0]
    v_pk_fma_f32 v[96:97], v[32:33], v[226:227], v[96:97] op_sel:[0,0,0] op_sel_hi:[0,1,1]
    v_pk_fma_f32 v[96:97], v[32:33], v[226:227], v[96:97] op_sel:[1,1,0] op_sel_hi:[1,0,1] neg_lo:[1,0,0]
    v_pk_fma_f32 v[98:99], v[32:33], v[96:97], v[98:99] op_sel:[0,0,0] op_sel_hi:[0,1,1]
    v_pk_fma_f32 v[98:99], v[32:33], v[96:97], v[98:99] op_sel:[1,1,0] op_sel_hi:[1,0,1] neg_lo:[1,0,0]
    v_pk_mul_f32 v[96:97], v[96:97], v[80:81] op_sel:[0,0] op_sel_hi:[1,0] neg_hi:[0,1]
    v_pk_fma_f32 v[100:101], v[32:33], v[98:99], v[100:101] op_sel:[0,0,0] op_sel_hi:[0,1,1]
    v_pk_fma_f32 v[100:101], v[32:33], v[98:99], v[100:101] op_sel:[1,1,0] op_sel_hi:[1,0,1] neg_lo:[1,0,0]
    buffer_load_dwordx4 a[200:203], v62, s[12:15], s60 offen offset:64
    v_pk_mul_f32 v[98:99], v[98:99], v[80:81] op_sel:[0,1] op_sel_hi:[1,1] neg_hi:[0,1]
    v_cvt_pk_bf16_f32 v64, v96, v98
    v_cvt_pk_bf16_f32 v72, v97, v99
    v_pk_fma_f32 v[102:103], v[32:33], v[100:101], v[102:103] op_sel:[0,0,0] op_sel_hi:[0,1,1]
    v_pk_fma_f32 v[102:103], v[32:33], v[100:101], v[102:103] op_sel:[1,1,0] op_sel_hi:[1,0,1] neg_lo:[1,0,0]
    v_pk_mul_f32 v[100:101], v[100:101], v[82:83] op_sel:[0,0] op_sel_hi:[1,0] neg_hi:[0,1]
    v_pk_fma_f32 v[104:105], v[32:33], v[102:103], v[104:105] op_sel:[0,0,0] op_sel_hi:[0,1,1]
    v_pk_fma_f32 v[104:105], v[32:33], v[102:103], v[104:105] op_sel:[1,1,0] op_sel_hi:[1,0,1] neg_lo:[1,0,0]
    ds_write_b128 v29, v[176:179] offset:17408
    v_pk_mul_f32 v[102:103], v[102:103], v[82:83] op_sel:[0,1] op_sel_hi:[1,1] neg_hi:[0,1]
    v_cvt_pk_bf16_f32 v65, v100, v102
    v_cvt_pk_bf16_f32 v73, v101, v103
L_pg3:
    s_cbranch_execz L_warm
    v_pk_fma_f32 v[106:107], v[32:33], v[104:105], v[106:107] op_sel:[0,0,0] op_sel_hi:[0,1,1]
    v_pk_fma_f32 v[106:107], v[32:33], v[104:105], v[106:107] op_sel:[1,1,0] op_sel_hi:[1,0,1] neg_lo:[1,0,0]
    v_pk_mul_f32 v[104:105], v[104:105], v[84:85] op_sel:[0,0] op_sel_hi:[1,0] neg_hi:[0,1]
    v_pk_fma_f32 v[108:109], v[32:33], v[106:107], v[108:109] op_sel:[0,0,0] op_sel_hi:[0,1,1]
    v_pk_fma_f32 v[108:109], v[32:33], v[106:107], v[108:109] op_sel:[1,1,0] op_sel_hi:[1,0,1] neg_lo:[1,0,0]
    v_pk_mul_f32 v[106:107], v[106:107], v[84:85] op_sel:[0,1] op_sel_hi:[1,1] neg_hi:[0,1]
    v_cvt_pk_bf16_f32 v66, v104, v106
    v_cvt_pk_bf16_f32 v74, v105, v107
    v_pk_fma_f32 v[110:111], v[32:33], v[108:109], v[110:111] op_sel:[0,0,0] op_sel_hi:[0,1,1]
    v_pk_fma_f32 v[110:111], v[32:33], v[108:109], v[110:111] op_sel:[1,1,0] op_sel_hi:[1,0,1] neg_lo:[1,0,0]
    v_pk_mul_f32 v[108:109], v[108:109], v[86:87] op_sel:[0,0] op_sel_hi:[1,0] neg_hi:[0,1]
    v_pk_fma_f32 v[112:113], v[32:33], v[110:111], v[112:113] op_sel:[0,0,0] op_sel_hi:[0,1,1]
    v_pk_fma_f32 v[112:113], v[32:33], v[110:111], v[112:113] op_sel:[1,1,0] op_sel_hi:[1,0,1] neg_lo:[1,0,0]
    v_pk_mul_f32 v[110:111], v[110:111], v[86:87] op_sel:[0,1] op_sel_hi:[1,1] neg_hi:[0,1]
    v_cvt_pk_bf16_f32 v67, v108, v110
    v_cvt_pk_bf16_f32 v75, v109, v111
    ds_write_b128 v30, v[64:67]
    ds_write_b128 v30, v[72:75] offset:8192
    ds_write_b128 v29, v[184:187] offset:19456
    buffer_load_dwordx4 a[204:207], v62, s[12:15], s60 offen offset:96
    v_pk_fma_f32 v[114:115], v[32:33], v[112:113], v[114:115] op_sel:[0,0,0] op_sel_hi:[0,1,1]
    v_pk_fma_f32 v[114:115], v[32:33], v[112:113], v[114:115] op_sel:[1,1,0] op_sel_hi:[1,0,1] neg_lo:[1,0,0]
    v_pk_mul_f32 v[112:113], v[112:113], v[88:89] op_sel:[0,0] op_sel_hi:[1,0] neg_hi:[0,1]
    v_pk_fma_f32 v[116:117], v[32:33], v[114:115], v[116:117] op_sel:[0,0,0] op_sel_hi:[0,1,1]
    v_pk_fma_f32 v[116:117], v[32:33], v[114:115], v[116:117] op_sel:[1,1,0] op_sel_hi:[1,0,1] neg_lo:[1,0,0]
    v_pk_mul_f32 v[114:115], v[114:115], v[88:89] op_sel:[0,1] op_sel_hi:[1,1] neg_hi:[0,1]
    v_cvt_pk_bf16_f32 v68, v112, v114
    v_cvt_pk_bf16_f32 v76, v113, v115
    v_pk_fma_f32 v[118:119], v[32:33], v[116:117], v[118:119] op_sel:[0,0,0] op_sel_hi:[0,1,1]
    v_pk_fma_f32 v[118:119], v[32:33], v[116:117], v[118:119] op_sel:[1,1,0] op_sel_hi:[1,0,1] neg_lo:[1,0,0]
    v_pk_mul_f32 v[116:117], v[116:117], v[90:91] op_sel:[0,0] op_sel_hi:[1,0] neg_hi:[0,1]
    v_pk_fma_f32 v[120:121], v[32:33], v[118:119], v[120:121] op_sel:[0,0,0] op_sel_hi:[0,1,1]
    v_pk_fma_f32 v[120:121], v[32:33], v[118:119], v[120:121] op_sel:[1,1,0] op_sel_hi:[1,0,1] neg_lo:[1,0,0]
    v_pk_mul_f32 v[118:119], v[118:119], v[90:91] op_sel:[0,1] op_sel_hi:[1,1] neg_hi:[0,1]
    v_cvt_pk_bf16_f32 v69, v116, v118
    v_cvt_pk_bf16_f32 v77, v117, v119
    v_pk_fma_f32 v[122:123], v[32:33], v[120:121], v[122:123] op_sel:[0,0,0] op_sel_hi:[0,1,1]
    v_pk_fma_f32 v[122:123], v[32:33], v[120:121], v[122:123] op_sel:[1,1,0] op_sel_hi:[1,0,1] neg_lo:[1,0,0]
    v_pk_mul_f32 v[120:121], v[120:121], v[92:93] op_sel:[0,0] op_sel_hi:[1,0] neg_hi:[0,1]
    v_pk_fma_f32 v[124:125], v[32:33], v[122:123], v[124:125] op_sel:[0,0,0] op_sel_hi:[0,1,1]
    v_pk_fma_f32 v[124:125], v[32:33], v[122:123], v[124:125] op_sel:[1,1,0] op_sel_hi:[1,0,1] neg_lo:[1,0,0]
    v_pk_mul_f32 v[122:123], v[122:123], v[92:93] op_sel:[0,1] op_sel_hi:[1,1] neg_hi:[0,1]
    v_cvt_pk_bf16_f32 v70, v120, v122
    v_cvt_pk_bf16_f32 v78, v121, v123
    v_pk_fma_f32 v[126:127], v[32:33], v[124:125], v[126:127] op_sel:[0,0,0] op_sel_hi:[0,1,1]
    v_pk_fma_f32 v[126:127], v[32:33], v[124:125], v[126:127] op_sel:[1,1,0] op_sel_hi:[1,0,1] neg_lo:[1,0,0]
    v_pk_mul_f32 v[124:125], v[124:125], v[94:95] op_sel:[0,0] op_sel_hi:[1,0] neg_hi:[0,1]
    v_pk_mul_f32 v[126:127], v[126:127], v[94:95] op_sel:[0,1] op_sel_hi:[1,1] neg_hi:[0,1]
    v_cvt_pk_bf16_f32 v71, v124, v126
    v_cvt_pk_bf16_f32 v79, v125, v127
    ds_write_b128 v31, v[68:71]
    ds_write_b128 v31, v[76:79] offset:8192
    s_waitcnt lgkmcnt(0)
    s_barrier
    ds_read_b64_tr_b16 v[208:209], v22 offset:12288
    ds_read_b64_tr_b16 v[210:211], v22 offset:12800
    ds_read_b128 a[0:3], v56 offset:0
    ds_read_b128 a[4:7], v57 offset:0
    ds_read_b64_tr_b16 v[212:213], v22 offset:13312
    ds_read_b64_tr_b16 v[214:215], v22 offset:13824
    ds_read_b128 a[8:11], v56 offset:2048
    ds_read_b128 a[12:15], v57 offset:2048
    s_waitcnt lgkmcnt(4)
    v_mfma_f32_32x32x16_bf16 v[128:143], a[0:3], v[208:211], 0
    ds_read_b64_tr_b16 v[216:217], v22 offset:14336
    ds_read_b64_tr_b16 v[218:219], v22 offset:14848
    v_mfma_f32_32x32x16_bf16 v[144:159], a[4:7], v[208:211], 0
    ds_read_b128 a[16:19], v56 offset:4096
    ds_read_b128 a[20:23], v57 offset:4096
    buffer_load_dwordx4 v2, s[16:19], s11 offen offset:1024 lds
    s_waitcnt lgkmcnt(4)
    v_mfma_f32_32x32x16_bf16 v[128:143], a[8:11], v[212:215], v[128:143]
    ds_read_b64_tr_b16 v[220:221], v22 offset:15360
    ds_read_b64_tr_b16 v[222:223], v22 offset:15872
    v_mfma_f32_32x32x16_bf16 v[144:159], a[12:15], v[212:215], v[144:159]
    ds_read_b128 a[24:27], v56 offset:6144
    ds_read_b128 a[28:31], v57 offset:6144
    buffer_load_dwordx4 v3, s[16:19], s11 offen offset:2048 lds
    s_waitcnt lgkmcnt(4)
    v_mfma_f32_32x32x16_bf16 v[128:143], a[16:19], v[216:219], v[128:143]
    ds_read_b64_tr_b16 v[208:209], v22 offset:16384
    ds_read_b64_tr_b16 v[210:211], v22 offset:16896
    v_xor_b32 v234, 16384, v56
    v_mfma_f32_32x32x16_bf16 v[144:159], a[20:23], v[216:219], v[144:159]
    ds_read_b128 a[32:35], v56 offset:8192
    ds_read_b128 a[36:39], v57 offset:8192
    buffer_load_dwordx4 v4, s[16:19], s11 offen offset:3072 lds
    v_xor_b32 v235, 17408, v56
    s_add_u32 m0, s67, 12288
    s_waitcnt lgkmcnt(4)
    v_mfma_f32_32x32x16_bf16 v[128:143], a[24:27], v[220:223], v[128:143]
    ds_read_b64_tr_b16 v[212:213], v22 offset:17408
    ds_read_b64_tr_b16 v[214:215], v22 offset:17920
    buffer_load_dwordx4 v9, s[44:47], s5 offen lds
    v_xor_b32 v240, 8192, v58
    v_mfma_f32_32x32x16_bf16 v[144:159], a[28:31], v[220:223], v[144:159]
    ds_read_b128 a[40:43], v56 offset:10240
    ds_read_b128 a[44:47], v57 offset:10240
    buffer_load_dwordx4 v10, s[44:47], s5 offen offset:1024 lds
    v_xor_b32 v241, 8736, v58
    s_waitcnt lgkmcnt(4)
    v_mfma_f32_32x32x16_bf16 v[128:143], a[32:35], v[208:211], v[128:143]
    ds_read_b64_tr_b16 v[216:217], v22 offset:18432
    ds_read_b64_tr_b16 v[218:219], v22 offset:18944
    v_xor_b32 v242, 8256, v58
    v_mfma_f32_32x32x16_bf16 v[144:159], a[36:39], v[208:211], v[144:159]
    ds_read_b128 a[48:51], v56 offset:12288
    ds_read_b128 a[52:55], v57 offset:12288
    buffer_load_dwordx4 v11, s[44:47], s5 offen offset:2048 lds
    v_xor_b32 v243, 8800, v58
    s_waitcnt lgkmcnt(4)
    v_mfma_f32_32x32x16_bf16 v[128:143], a[40:43], v[212:215], v[128:143]
    ds_read_b64_tr_b16 v[220:221], v22 offset:19456
    ds_read_b64_tr_b16 v[222:223], v22 offset:19968
    v_mov_b32 v248, 0
    v_and_b32 v252, 1, v0
    v_mfma_f32_32x32x16_bf16 v[144:159], a[44:47], v[212:215], v[144:159]
    ds_read_b128 a[56:59], v56 offset:14336
    ds_read_b128 a[60:63], v57 offset:14336
    buffer_load_dwordx4 v12, s[44:47], s5 offen offset:3072 lds
    s_waitcnt lgkmcnt(4)
    v_mfma_f32_32x32x16_bf16 v[128:143], a[48:51], v[216:219], v[128:143]
    ds_read_b128 v[208:211], v17 offset:20480
    ds_read_b64_tr_b16 a[64:65], v58 offset:0
    ds_read_b64_tr_b16 a[66:67], v59 offset:0
    v_lshlrev_b32 v252, 2, v252
    s_add_u32 m0, s67, 16384
    s_add_u32 s68, s5, 57344
    v_mfma_f32_32x32x16_bf16 v[144:159], a[52:55], v[216:219], v[144:159]
    ds_read_b64_tr_b16 a[68:69], v60 offset:0
    ds_read_b64_tr_b16 a[70:71], v61 offset:0
    buffer_load_dwordx4 v9, s[44:47], s68 offen lds
    s_add_u32 s83, s78, 8192
    s_waitcnt lgkmcnt(5)
    v_mfma_f32_32x32x16_bf16 v[128:143], a[56:59], v[220:223], v[128:143]
    ds_read_b128 v[212:215], v18 offset:20480
    ds_read_b64_tr_b16 a[72:73], v58 offset:2048
    ds_read_b64_tr_b16 a[74:75], v59 offset:2048
    s_add_u32 s84, s78, 16384
    v_mfma_f32_32x32x16_bf16 v[144:159], a[60:63], v[220:223], v[144:159]
    ds_read_b64_tr_b16 a[76:77], v60 offset:2048
    ds_read_b64_tr_b16 a[78:79], v61 offset:2048
    buffer_load_dwordx4 v10, s[44:47], s68 offen offset:1024 lds
    s_add_u32 s85, s78, 24576
    s_waitcnt lgkmcnt(5)
    v_mfma_f32_32x32x16_bf16 v[128:143], a[64:67], v[208:211], v[128:143]
    ds_read_b128 v[216:219], v19 offset:20480
    ds_read_b64_tr_b16 a[80:81], v58 offset:4096
    ds_read_b64_tr_b16 a[82:83], v59 offset:4096
    s_add_u32 s86, s78, 32768
    v_mfma_f32_32x32x16_bf16 v[144:159], a[68:71], v[208:211], v[144:159]
    ds_read_b64_tr_b16 a[84:85], v60 offset:4096
    ds_read_b64_tr_b16 a[86:87], v61 offset:4096
    buffer_load_dwordx4 v11, s[44:47], s68 offen offset:2048 lds
    s_add_u32 s87, s78, 40960
    s_waitcnt lgkmcnt(5)
    v_mfma_f32_32x32x16_bf16 v[128:143], a[72:75], v[212:215], v[128:143]
    ds_read_b128 v[220:223], v20 offset:20480
    ds_read_b64_tr_b16 a[88:89], v58 offset:6144
    ds_read_b64_tr_b16 a[90:91], v59 offset:6144
    v_mfma_f32_32x32x16_bf16 v[144:159], a[76:79], v[212:215], v[144:159]
    ds_read_b64_tr_b16 a[92:93], v60 offset:6144
    ds_read_b64_tr_b16 a[94:95], v61 offset:6144
    buffer_load_dwordx4 v12, s[44:47], s68 offen offset:3072 lds
    s_waitcnt lgkmcnt(5)
    v_mfma_f32_32x32x16_bf16 v[128:143], a[80:83], v[216:219], v[128:143]
    ds_read_b64_tr_b16 v[208:209], v22 offset:0
    ds_read_b64_tr_b16 v[210:211], v22 offset:512
    v_mfma_f32_32x32x16_bf16 v[144:159], a[84:87], v[216:219], v[144:159]
    ds_read_b128 a[96:99], v234 offset:0
    ds_read_b128 a[100:103], v235 offset:0
    s_add_u32 m0, s67, 20480
    s_waitcnt lgkmcnt(4)
    v_mfma_f32_32x32x16_bf16 v[128:143], a[88:91], v[220:223], v[128:143]
    ds_read_b64_tr_b16 v[212:213], v22 offset:1024
    ds_read_b64_tr_b16 v[214:215], v22 offset:1536
    buffer_load_dwordx4 v9, s[44:47], s9 offen lds
    v_mfma_f32_32x32x16_bf16 v[144:159], a[92:95], v[220:223], v[144:159]
    ds_read_b128 a[104:107], v234 offset:2048
    ds_read_b128 a[108:111], v235 offset:2048
    buffer_load_dwordx4 v10, s[44:47], s9 offen offset:1024 lds
    s_waitcnt lgkmcnt(4)
    v_mfma_f32_32x32x16_bf16 v[128:143], a[96:99], v[208:211], v[128:143]
    ds_read_b64_tr_b16 v[216:217], v22 offset:2048
    ds_read_b64_tr_b16 v[218:219], v22 offset:2560
    v_mfma_f32_32x32x16_bf16 v[144:159], a[100:103], v[208:211], v[144:159]
    ds_read_b128 a[112:115], v234 offset:4096
    ds_read_b128 a[116:119], v235 offset:4096
    buffer_load_dwordx4 v11, s[44:47], s9 offen offset:2048 lds
    s_waitcnt lgkmcnt(4)
    v_mfma_f32_32x32x16_bf16 v[128:143], a[104:107], v[212:215], v[128:143]
    ds_read_b64_tr_b16 v[220:221], v22 offset:3072
    ds_read_b64_tr_b16 v[222:223], v22 offset:3584
    v_mfma_f32_32x32x16_bf16 v[144:159], a[108:111], v[212:215], v[144:159]
    ds_read_b128 a[120:123], v234 offset:6144
    ds_read_b128 a[124:127], v235 offset:6144
    buffer_load_dwordx4 v12, s[44:47], s9 offen offset:3072 lds
    s_waitcnt lgkmcnt(4)
    v_mfma_f32_32x32x16_bf16 v[128:143], a[112:115], v[216:219], v[128:143]
    ds_read_b64_tr_b16 v[208:209], v22 offset:4096
    ds_read_b64_tr_b16 v[210:211], v22 offset:4608
    s_add_u32 m0, s67, 0
    s_add_u32 s68, s9, 57344
    v_mfma_f32_32x32x16_bf16 v[144:159], a[116:119], v[216:219], v[144:159]
    ds_read_b128 a[128:131], v234 offset:8192
    ds_read_b128 a[132:135], v235 offset:8192
    buffer_load_dwordx4 v9, s[44:47], s68 offen lds
    s_waitcnt lgkmcnt(4)
    v_mfma_f32_32x32x16_bf16 v[128:143], a[120:123], v[220:223], v[128:143]
    ds_read_b64_tr_b16 v[212:213], v22 offset:5120
    ds_read_b64_tr_b16 v[214:215], v22 offset:5632
    v_mfma_f32_32x32x16_bf16 v[144:159], a[124:127], v[220:223], v[144:159]
    ds_read_b128 a[136:139], v234 offset:10240
    ds_read_b128 a[140:143], v235 offset:10240
    buffer_load_dwordx4 v10, s[44:47], s68 offen offset:1024 lds
    s_waitcnt lgkmcnt(4)
    v_mfma_f32_32x32x16_bf16 v[128:143], a[128:131], v[208:211], v[128:143]
    ds_read_b64_tr_b16 v[216:217], v22 offset:6144
    ds_read_b64_tr_b16 v[218:219], v22 offset:6656
    v_mfma_f32_32x32x16_bf16 v[144:159], a[132:135], v[208:211], v[144:159]
    ds_read_b128 a[144:147], v234 offset:12288
    ds_read_b128 a[148:151], v235 offset:12288
    buffer_load_dwordx4 v11, s[44:47], s68 offen offset:2048 lds
    s_waitcnt vmcnt(23) lgkmcnt(4)
    v_mfma_f32_32x32x16_bf16 v[128:143], a[136:139], v[212:215], v[128:143]
    ds_read_b64_tr_b16 v[220:221], v22 offset:7168
    ds_read_b64_tr_b16 v[222:223], v22 offset:7680
    v_mfma_f32_32x32x16_bf16 v[144:159], a[140:143], v[212:215], v[144:159]
    ds_read_b128 a[152:155], v234 offset:14336
    ds_read_b128 a[156:159], v235 offset:14336
    buffer_load_dwordx4 v12, s[44:47], s68 offen offset:3072 lds
    s_waitcnt vmcnt(16) lgkmcnt(4)
    v_mfma_f32_32x32x16_bf16 v[128:143], a[144:147], v[216:219], v[128:143]
    ds_read_b128 v[208:211], v17 offset:8192
    ds_read_b64_tr_b16 a[160:161], v240 offset:0
    ds_read_b64_tr_b16 a[162:163], v241 offset:0
    s_add_u32 m0, s67, 4096
    v_mfma_f32_32x32x16_bf16 v[144:159], a[148:151], v[216:219], v[144:159]
    ds_read_b64_tr_b16 a[164:165], v242 offset:0
    ds_read_b64_tr_b16 a[166:167], v243 offset:0
    buffer_load_dwordx4 v1, s[16:19], s60 offen lds
    s_waitcnt lgkmcnt(5)
    v_mfma_f32_32x32x16_bf16 v[128:143], a[152:155], v[220:223], v[128:143]
    ds_read_b128 v[212:215], v18 offset:8192
    ds_read_b64_tr_b16 a[168:169], v240 offset:2048
    ds_read_b64_tr_b16 a[170:171], v241 offset:2048
    v_mfma_f32_32x32x16_bf16 v[144:159], a[156:159], v[220:223], v[144:159]
    ds_read_b64_tr_b16 a[172:173], v242 offset:2048
    ds_read_b64_tr_b16 a[174:175], v243 offset:2048
    buffer_load_dwordx4 v2, s[16:19], s60 offen offset:1024 lds
    s_waitcnt lgkmcnt(5)
    v_mfma_f32_32x32x16_bf16 v[128:143], a[160:163], v[208:211], v[128:143]
    ds_read_b128 v[216:219], v19 offset:8192
    ds_read_b64_tr_b16 a[176:177], v240 offset:4096
    ds_read_b64_tr_b16 a[178:179], v241 offset:4096
    v_mfma_f32_32x32x16_bf16 v[144:159], a[164:167], v[208:211], v[144:159]
    ds_read_b64_tr_b16 a[180:181], v242 offset:4096
    ds_read_b64_tr_b16 a[182:183], v243 offset:4096
    buffer_load_dwordx4 v3, s[16:19], s60 offen offset:2048 lds
    s_waitcnt lgkmcnt(5)
    v_mfma_f32_32x32x16_bf16 v[128:143], a[168:171], v[212:215], v[128:143]
    ds_read_b128 v[220:223], v20 offset:8192
    ds_read_b64_tr_b16 a[184:185], v240 offset:6144
    ds_read_b64_tr_b16 a[186:187], v241 offset:6144
    v_mfma_f32_32x32x16_bf16 v[144:159], a[172:175], v[212:215], v[144:159]
    ds_read_b64_tr_b16 a[188:189], v242 offset:6144
    ds_read_b64_tr_b16 a[190:191], v243 offset:6144
    buffer_load_dwordx4 v4, s[16:19], s60 offen offset:3072 lds
    s_waitcnt vmcnt(19) lgkmcnt(5)
    v_mfma_f32_32x32x16_bf16 v[128:143], a[176:179], v[216:219], v[128:143]
    ds_read_b64_tr_b16 v[208:209], v22 offset:12288
    ds_read_b64_tr_b16 v[210:211], v22 offset:12800
    v_mfma_f32_32x32x16_bf16 v[144:159], a[180:183], v[216:219], v[144:159]
    s_add_u32 m0, s67, 8192
    s_waitcnt vmcnt(18) lgkmcnt(2)
    v_mfma_f32_32x32x16_bf16 v[128:143], a[184:187], v[220:223], v[128:143]
    ds_read_b64_tr_b16 v[212:213], v22 offset:13312
    ds_read_b64_tr_b16 v[214:215], v22 offset:13824
    buffer_load_dwordx4 v9, s[44:47], s6 offen lds
    v_mfma_f32_32x32x16_bf16 v[144:159], a[188:191], v[220:223], v[144:159]
    buffer_load_dwordx4 v10, s[44:47], s6 offen offset:1024 lds
    s_waitcnt vmcnt(19) lgkmcnt(2)
    v_mfma_f32_32x32x16_bf16 v[160:175], a[0:3], v[208:211], 0
    ds_read_b64_tr_b16 v[216:217], v22 offset:14336
    ds_read_b64_tr_b16 v[218:219], v22 offset:14848
    v_mfma_f32_32x32x16_bf16 v[176:191], a[4:7], v[208:211], 0
    buffer_load_dwordx4 v11, s[44:47], s6 offen offset:2048 lds
    s_waitcnt vmcnt(19) lgkmcnt(2)
    v_mfma_f32_32x32x16_bf16 v[160:175], a[8:11], v[212:215], v[160:175]
    ds_read_b64_tr_b16 v[220:221], v22 offset:15360
    ds_read_b64_tr_b16 v[222:223], v22 offset:15872
    v_cvt_pk_bf16_f32 v96, v128, v129
    v_cvt_pk_bf16_f32 v97, v130, v131
    v_cvt_pk_bf16_f32 v98, v132, v133
    v_cvt_pk_bf16_f32 v99, v134, v135
    v_mfma_f32_32x32x16_bf16 v[176:191], a[12:15], v[212:215], v[176:191]
    buffer_load_dwordx4 v12, s[44:47], s6 offen offset:3072 lds
    buffer_store_dwordx4 v[96:99], v23, s[52:55], s33 offen offset:0 sc1
    v_cvt_pk_bf16_f32 v100, v136, v137
    v_cvt_pk_bf16_f32 v101, v138, v139
    v_cvt_pk_bf16_f32 v102, v140, v141
    v_cvt_pk_bf16_f32 v103, v142, v143
    s_waitcnt vmcnt(20) lgkmcnt(2)
    v_mfma_f32_32x32x16_bf16 v[160:175], a[16:19], v[216:219], v[160:175]
    ds_read_b64_tr_b16 v[208:209], v22 offset:16384
    ds_read_b64_tr_b16 v[210:211], v22 offset:16896
    buffer_store_dwordx4 v[100:103], v23, s[52:55], s33 offen offset:1024 sc1
    v_cvt_pk_bf16_f32 v104, v144, v145
    v_cvt_pk_bf16_f32 v105, v146, v147
    v_cvt_pk_bf16_f32 v106, v148, v149
    v_cvt_pk_bf16_f32 v107, v150, v151
    s_add_u32 m0, s67, 12288
    s_add_u32 s68, s6, 57344
    v_mfma_f32_32x32x16_bf16 v[176:191], a[20:23], v[216:219], v[176:191]
    buffer_load_dwordx4 v9, s[44:47], s68 offen lds
    buffer_store_dwordx4 v[104:107], v24, s[52:55], s33 offen offset:0 sc1
    v_cvt_pk_bf16_f32 v108, v152, v153
    v_cvt_pk_bf16_f32 v109, v154, v155
    v_cvt_pk_bf16_f32 v110, v156, v157
    v_cvt_pk_bf16_f32 v111, v158, v159
    buffer_store_dwordx4 v[108:111], v24, s[52:55], s33 offen offset:1024 sc1
    s_waitcnt vmcnt(23) lgkmcnt(2)
    v_mfma_f32_32x32x16_bf16 v[160:175], a[24:27], v[220:223], v[160:175]
    ds_read_b64_tr_b16 v[212:213], v22 offset:17408
    ds_read_b64_tr_b16 v[214:215], v22 offset:17920
    v_mfma_f32_32x32x16_bf16 v[176:191], a[28:31], v[220:223], v[176:191]
    buffer_load_dwordx4 v10, s[44:47], s68 offen offset:1024 lds
    s_waitcnt vmcnt(23) lgkmcnt(2)
    v_mfma_f32_32x32x16_bf16 v[160:175], a[32:35], v[208:211], v[160:175]
    ds_read_b64_tr_b16 v[216:217], v22 offset:18432
    ds_read_b64_tr_b16 v[218:219], v22 offset:18944
    v_mfma_f32_32x32x16_bf16 v[176:191], a[36:39], v[208:211], v[176:191]
    buffer_load_dwordx4 v11, s[44:47], s68 offen offset:2048 lds
    s_waitcnt vmcnt(23) lgkmcnt(2)
    v_mfma_f32_32x32x16_bf16 v[160:175], a[40:43], v[212:215], v[160:175]
    ds_read_b64_tr_b16 v[220:221], v22 offset:19456
    ds_read_b64_tr_b16 v[222:223], v22 offset:19968
    v_mfma_f32_32x32x16_bf16 v[176:191], a[44:47], v[212:215], v[176:191]
    buffer_load_dwordx4 v12, s[44:47], s68 offen offset:3072 lds
    s_waitcnt lgkmcnt(2)
    v_mfma_f32_32x32x16_bf16 v[160:175], a[48:51], v[216:219], v[160:175]
    s_lshl_b32 s69, s66, 7
    s_add_u32 m0, s67, 16384
    v_mfma_f32_32x32x16_bf16 v[176:191], a[52:55], v[216:219], v[176:191]
    buffer_load_dwordx4 v1, s[12:15], s61 offen lds
    s_add_u32 s69, s69, 156672
    v_lshrrev_b32 v240, 5, v0
    s_waitcnt lgkmcnt(0)
    v_mfma_f32_32x32x16_bf16 v[160:175], a[56:59], v[220:223], v[160:175]
    v_lshl_add_u32 v240, v240, 4, s69
    v_lshlrev_b32 v224, 16, v200
    v_mfma_f32_32x32x16_bf16 v[176:191], a[60:63], v[220:223], v[176:191]
    buffer_load_dwordx4 v2, s[12:15], s61 offen offset:1024 lds
    v_and_b32 v225, 0xffff0000, v200
    v_mfma_f32_32x32x16_bf16 v[160:175], a[64:67], a[192:195], v[160:175]
    v_lshlrev_b32 v226, 16, v201
    v_and_b32 v227, 0xffff0000, v201
    v_lshlrev_b32 v228, 16, v202
    v_mfma_f32_32x32x16_bf16 v[176:191], a[68:71], a[192:195], v[176:191]
    buffer_load_dwordx4 v3, s[12:15], s61 offen offset:2048 lds
    v_and_b32 v229, 0xffff0000, v202
    v_mfma_f32_32x32x16_bf16 v[160:175], a[72:75], a[196:199], v[160:175]
    v_lshlrev_b32 v230, 16, v203
    v_and_b32 v231, 0xffff0000, v203
    v_mfma_f32_32x32x16_bf16 v[176:191], a[76:79], a[196:199], v[176:191]
    buffer_load_dwordx4 v4, s[12:15], s61 offen offset:3072 lds
    v_lshlrev_b32 v232, 16, v204
    v_and_b32 v233, 0xffff0000, v204
    s_waitcnt vmcnt(27)
    v_mfma_f32_32x32x16_bf16 v[160:175], a[80:83], a[200:203], v[160:175]
    ds_read_b64_tr_b16 v[208:209], v22 offset:20480
    ds_read_b64_tr_b16 v[210:211], v22 offset:20992
    v_lshlrev_b32 v234, 16, v205
    v_mfma_f32_32x32x16_bf16 v[176:191], a[84:87], a[200:203], v[176:191]
    v_and_b32 v235, 0xffff0000, v205
    v_lshlrev_b32 v236, 16, v206
    s_waitcnt vmcnt(26)
    v_mfma_f32_32x32x16_bf16 v[160:175], a[88:91], a[204:207], v[160:175]
    ds_read_b64_tr_b16 v[212:213], v22 offset:21504
    ds_read_b64_tr_b16 v[214:215], v22 offset:22016
    v_and_b32 v237, 0xffff0000, v206
    v_mfma_f32_32x32x16_bf16 v[176:191], a[92:95], a[204:207], v[176:191]
    v_lshlrev_b32 v238, 16, v207
    v_and_b32 v239, 0xffff0000, v207
    s_waitcnt vmcnt(25) lgkmcnt(2)
    v_mfma_f32_32x32x16_bf16 v[160:175], a[96:99], v[208:211], v[160:175]
    ds_read_b64_tr_b16 v[216:217], v22 offset:22528
    ds_read_b64_tr_b16 v[218:219], v22 offset:23040
    ds_read_b128 v[192:195], v240 offset:0
    s_add_u32 m0, s67, 20480
    v_mfma_f32_32x32x16_bf16 v[176:191], a[100:103], v[208:211], v[176:191]
    buffer_load_dwordx4 v9, s[44:47], s10 offen lds
    ds_read_b128 v[196:199], v240 offset:32
    ds_read_b128 v[200:203], v240 offset:64
    s_waitcnt vmcnt(25) lgkmcnt(5)
    v_mfma_f32_32x32x16_bf16 v[160:175], a[104:107], v[212:215], v[160:175]
    ds_read_b64_tr_b16 v[220:221], v22 offset:23552
    ds_read_b64_tr_b16 v[222:223], v22 offset:24064
    ds_read_b128 v[204:207], v240 offset:96
    v_mfma_f32_32x32x16_bf16 v[176:191], a[108:111], v[212:215], v[176:191]
    buffer_load_dwordx4 v10, s[44:47], s10 offen offset:1024 lds
    v_mul_f32 v224, v47, v224
    v_mul_f32 v225, v47, v225
    s_waitcnt vmcnt(25) lgkmcnt(6)
    v_mfma_f32_32x32x16_bf16 v[160:175], a[112:115], v[216:219], v[160:175]
    ds_read_b64_tr_b16 v[208:209], v22 offset:0
    ds_read_b64_tr_b16 v[210:211], v22 offset:512
    v_mul_f32 v226, v47, v226
    v_mfma_f32_32x32x16_bf16 v[176:191], a[116:119], v[216:219], v[176:191]
    buffer_load_dwordx4 v11, s[44:47], s10 offen offset:2048 lds
    v_mul_f32 v227, v47, v227
    s_waitcnt vmcnt(25) lgkmcnt(3)
    v_mfma_f32_32x32x16_bf16 v[160:175], a[120:123], v[220:223], v[160:175]
    ds_read_b64_tr_b16 v[212:213], v22 offset:1024
    ds_read_b64_tr_b16 v[214:215], v22 offset:1536
    v_mul_f32 v228, v47, v228
    v_mul_f32 v229, v47, v229
    v_mfma_f32_32x32x16_bf16 v[176:191], a[124:127], v[220:223], v[176:191]
    buffer_load_dwordx4 v12, s[44:47], s10 offen offset:3072 lds
    v_mul_f32 v230, v47, v230
    s_waitcnt vmcnt(25) lgkmcnt(2)
    v_mfma_f32_32x32x16_bf16 v[160:175], a[128:131], v[208:211], v[160:175]
    ds_read_b64_tr_b16 v[216:217], v22 offset:2048
    ds_read_b64_tr_b16 v[218:219], v22 offset:2560
    v_mul_f32 v231, v47, v231
    s_add_u32 m0, s67, 0
    s_add_u32 s68, s10, 57344
    v_mfma_f32_32x32x16_bf16 v[176:191], a[132:135], v[208:211], v[176:191]
    buffer_load_dwordx4 v9, s[44:47], s68 offen lds
    v_mul_f32 v232, v47, v232
    s_waitcnt vmcnt(25) lgkmcnt(2)
    v_mfma_f32_32x32x16_bf16 v[160:175], a[136:139], v[212:215], v[160:175]
    ds_read_b64_tr_b16 v[220:221], v22 offset:3072
    ds_read_b64_tr_b16 v[222:223], v22 offset:3584
    v_mul_f32 v233, v47, v233
    v_mul_f32 v234, v47, v234
    v_mfma_f32_32x32x16_bf16 v[176:191], a[140:143], v[212:215], v[176:191]
    buffer_load_dwordx4 v10, s[44:47], s68 offen offset:1024 lds
    v_mul_f32 v235, v47, v235
    s_waitcnt vmcnt(22) lgkmcnt(2)
    v_mfma_f32_32x32x16_bf16 v[160:175], a[144:147], v[216:219], v[160:175]
    ds_read_b128 v[208:211], v17 offset:4096
    v_mul_f32 v236, v47, v236
    v_mul_f32 v237, v47, v237
    v_mfma_f32_32x32x16_bf16 v[176:191], a[148:151], v[216:219], v[176:191]
    buffer_load_dwordx4 v11, s[44:47], s68 offen offset:2048 lds
    v_mul_f32 v238, v47, v238
    v_mul_f32 v239, v47, v239
    s_waitcnt lgkmcnt(1)
    v_mfma_f32_32x32x16_bf16 v[160:175], a[152:155], v[220:223], v[160:175]
    ds_read_b128 v[212:215], v18 offset:4096
    v_mul_f32 v192, v224, v192
    v_mfma_f32_32x32x16_bf16 v[176:191], a[156:159], v[220:223], v[176:191]
    buffer_load_dwordx4 v12, s[44:47], s68 offen offset:3072 lds
    v_mul_f32 v193, v225, v193
    v_mul_f32 v194, v226, v194
    s_waitcnt lgkmcnt(1)
    v_mfma_f32_32x32x16_bf16 v[160:175], a[160:163], v[208:211], v[160:175]
    ds_read_b128 v[216:219], v19 offset:4096
    v_mul_f32 v195, v227, v195
    v_mul_f32 v196, v228, v196
    v_mfma_f32_32x32x16_bf16 v[176:191], a[164:167], v[208:211], v[176:191]
    v_mul_f32 v197, v229, v197
    s_waitcnt lgkmcnt(1)
    v_mfma_f32_32x32x16_bf16 v[160:175], a[168:171], v[212:215], v[160:175]
    ds_read_b128 v[220:223], v20 offset:4096
    v_mul_f32 v198, v230, v198
    v_mul_f32 v199, v231, v199
    v_mfma_f32_32x32x16_bf16 v[176:191], a[172:175], v[212:215], v[176:191]
    v_mul_f32 v200, v232, v200
    v_mul_f32 v201, v233, v201
    s_waitcnt vmcnt(23) lgkmcnt(1)
    v_mfma_f32_32x32x16_bf16 v[160:175], a[176:179], v[216:219], v[160:175]
    ds_read_b64_tr_b16 v[208:209], v22 offset:8192
    ds_read_b64_tr_b16 v[210:211], v22 offset:8704
    v_mul_f32 v202, v234, v202
    v_mul_f32 v203, v235, v203
    v_mfma_f32_32x32x16_bf16 v[176:191], a[180:183], v[216:219], v[176:191]
    v_mul_f32 v204, v236, v204
    s_add_u32 m0, s67, 4096
    s_waitcnt vmcnt(22) lgkmcnt(2)
    v_mfma_f32_32x32x16_bf16 v[160:175], a[184:187], v[220:223], v[160:175]
    ds_read_b64_tr_b16 v[212:213], v22 offset:9216
    ds_read_b64_tr_b16 v[214:215], v22 offset:9728
    buffer_load_dwordx4 v1, s[16:19], s61 offen lds
    v_mul_f32 v205, v237, v205
    v_mfma_f32_32x32x16_bf16 v[176:191], a[188:191], v[220:223], v[176:191]
    buffer_load_dwordx4 v2, s[16:19], s61 offen offset:1024 lds
    v_mul_f32 v206, v238, v206
    v_mul_f32 v207, v239, v207
    s_waitcnt vmcnt(23) lgkmcnt(2)
    v_mfma_f32_32x32x16_bf16 v[128:143], a[0:3], v[208:211], 0
    ds_read_b64_tr_b16 v[216:217], v22 offset:10240
    ds_read_b64_tr_b16 v[218:219], v22 offset:10752
    s_waitcnt vmcnt(17)
    buffer_store_dword v248, v25, s[52:55], s3 offen offset:0 sc1
    v_mfma_f32_32x32x16_bf16 v[144:159], a[4:7], v[208:211], 0
    buffer_load_dwordx4 v3, s[16:19], s61 offen offset:2048 lds
    s_waitcnt lgkmcnt(2)
    v_mfma_f32_32x32x16_bf16 v[128:143], a[8:11], v[212:215], v[128:143]
    ds_read_b64_tr_b16 v[220:221], v22 offset:11264
    ds_read_b64_tr_b16 v[222:223], v22 offset:11776
    v_cvt_pk_bf16_f32 v96, v160, v161
    v_cvt_pk_bf16_f32 v97, v162, v163
    v_cvt_pk_bf16_f32 v98, v164, v165
    v_cvt_pk_bf16_f32 v99, v166, v167
    v_mfma_f32_32x32x16_bf16 v[144:159], a[12:15], v[212:215], v[144:159]
    buffer_load_dwordx4 v4, s[16:19], s61 offen offset:3072 lds
    buffer_store_dwordx4 v[96:99], v23, s[52:55], s34 offen offset:0 sc1
    v_cvt_pk_bf16_f32 v100, v168, v169
    v_cvt_pk_bf16_f32 v101, v170, v171
    v_cvt_pk_bf16_f32 v102, v172, v173
    v_cvt_pk_bf16_f32 v103, v174, v175
    s_waitcnt lgkmcnt(2)
    v_mfma_f32_32x32x16_bf16 v[128:143], a[16:19], v[216:219], v[128:143]
    ds_read_b64_tr_b16 v[208:209], v22 offset:12288
    ds_read_b64_tr_b16 v[210:211], v22 offset:12800
    buffer_store_dwordx4 v[100:103], v23, s[52:55], s34 offen offset:1024 sc1
    v_cvt_pk_bf16_f32 v104, v176, v177
    v_cvt_pk_bf16_f32 v105, v178, v179
    v_cvt_pk_bf16_f32 v106, v180, v181
    v_cvt_pk_bf16_f32 v107, v182, v183
    s_add_u32 m0, s67, 8192
    v_mfma_f32_32x32x16_bf16 v[144:159], a[20:23], v[216:219], v[144:159]
    buffer_load_dwordx4 v9, s[44:47], s7 offen lds
    buffer_store_dwordx4 v[104:107], v24, s[52:55], s34 offen offset:0 sc1
    v_cvt_pk_bf16_f32 v108, v184, v185
    v_cvt_pk_bf16_f32 v109, v186, v187
    v_cvt_pk_bf16_f32 v110, v188, v189
    v_cvt_pk_bf16_f32 v111, v190, v191
    buffer_store_dwordx4 v[108:111], v24, s[52:55], s34 offen offset:1024 sc1
    s_waitcnt vmcnt(24) lgkmcnt(2)
    v_mfma_f32_32x32x16_bf16 v[128:143], a[24:27], v[220:223], v[128:143]
    ds_read_b64_tr_b16 v[212:213], v22 offset:13312
    ds_read_b64_tr_b16 v[214:215], v22 offset:13824
    v_mfma_f32_32x32x16_bf16 v[144:159], a[28:31], v[220:223], v[144:159]
    buffer_load_dwordx4 v10, s[44:47], s7 offen offset:1024 lds
    s_waitcnt vmcnt(24) lgkmcnt(2)
    v_mfma_f32_32x32x16_bf16 v[128:143], a[32:35], v[208:211], v[128:143]
    ds_read_b64_tr_b16 v[216:217], v22 offset:14336
    ds_read_b64_tr_b16 v[218:219], v22 offset:14848
    v_mfma_f32_32x32x16_bf16 v[144:159], a[36:39], v[208:211], v[144:159]
    buffer_load_dwordx4 v11, s[44:47], s7 offen offset:2048 lds
    s_waitcnt vmcnt(24) lgkmcnt(2)
    v_mfma_f32_32x32x16_bf16 v[128:143], a[40:43], v[212:215], v[128:143]
    ds_read_b64_tr_b16 v[220:221], v22 offset:15360
    ds_read_b64_tr_b16 v[222:223], v22 offset:15872
    v_mfma_f32_32x32x16_bf16 v[144:159], a[44:47], v[212:215], v[144:159]
    buffer_load_dwordx4 v12, s[44:47], s7 offen offset:3072 lds
    s_waitcnt vmcnt(21) lgkmcnt(2)
    v_mfma_f32_32x32x16_bf16 v[128:143], a[48:51], v[216:219], v[128:143]
    ds_read_b128 v[208:211], v17 offset:16384
    s_add_u32 m0, s67, 12288
    s_add_u32 s68, s7, 57344
    v_mfma_f32_32x32x16_bf16 v[144:159], a[52:55], v[216:219], v[144:159]
    buffer_load_dwordx4 v9, s[44:47], s68 offen lds
    v_add_u32 v13, s81, v17
    s_waitcnt lgkmcnt(1)
    v_mfma_f32_32x32x16_bf16 v[128:143], a[56:59], v[220:223], v[128:143]
    ds_read_b128 v[212:215], v18 offset:16384
    v_add_u32 v14, s81, v18
    v_mfma_f32_32x32x16_bf16 v[144:159], a[60:63], v[220:223], v[144:159]
    buffer_load_dwordx4 v10, s[44:47], s68 offen offset:1024 lds
    v_add_u32 v15, s81, v19
    s_waitcnt lgkmcnt(1)
L_pg4:
    s_cbranch_execz L_warm
    v_mfma_f32_32x32x16_bf16 v[128:143], a[64:67], v[208:211], v[128:143]
    ds_read_b128 v[216:219], v19 offset:16384
    v_add_u32 v16, s81, v20
    v_mfma_f32_32x32x16_bf16 v[144:159], a[68:71], v[208:211], v[144:159]
    buffer_load_dwordx4 v11, s[44:47], s68 offen offset:2048 lds
    v_add_u32 v21, s81, v22
    s_waitcnt lgkmcnt(1)
    v_mfma_f32_32x32x16_bf16 v[128:143], a[72:75], v[212:215], v[128:143]
    ds_read_b128 v[220:223], v20 offset:16384
    v_bfe_u32 v241, v0, 1, 1
    v_bfe_u32 v242, v0, 2, 1
    v_mfma_f32_32x32x16_bf16 v[144:159], a[76:79], v[212:215], v[144:159]
    buffer_load_dwordx4 v12, s[44:47], s68 offen offset:3072 lds
    s_waitcnt vmcnt(24) lgkmcnt(1)
    v_mfma_f32_32x32x16_bf16 v[128:143], a[80:83], v[216:219], v[128:143]
    ds_read_b64_tr_b16 v[208:209], v22 offset:20480
    ds_read_b64_tr_b16 v[210:211], v22 offset:20992
    v_and_b32 v244, 1, v0
    v_mfma_f32_32x32x16_bf16 v[144:159], a[84:87], v[216:219], v[144:159]
    v_lshrrev_b32 v245, 5, v0
    s_add_u32 m0, s67, 16384
    s_waitcnt vmcnt(23) lgkmcnt(2)
    v_mfma_f32_32x32x16_bf16 v[128:143], a[88:91], v[220:223], v[128:143]
    ds_read_b64_tr_b16 v[212:213], v22 offset:21504
    ds_read_b64_tr_b16 v[214:215], v22 offset:22016
    buffer_load_dwordx4 v1, s[12:15], s32 offen lds
    v_bfe_u32 v243, v0, 3, 2
    v_mfma_f32_32x32x16_bf16 v[144:159], a[92:95], v[220:223], v[144:159]
    buffer_load_dwordx4 v2, s[12:15], s32 offen offset:1024 lds
    v_lshl_add_u32 v241, v243, 1, v241
    s_waitcnt vmcnt(24) lgkmcnt(2)
    v_mfma_f32_32x32x16_bf16 v[128:143], a[96:99], v[208:211], v[128:143]
    ds_read_b64_tr_b16 v[216:217], v22 offset:22528
    ds_read_b64_tr_b16 v[218:219], v22 offset:23040
    v_xor_b32 v242, v242, v245
    v_mfma_f32_32x32x16_bf16 v[144:159], a[100:103], v[208:211], v[144:159]
    buffer_load_dwordx4 v3, s[12:15], s32 offen offset:2048 lds
    v_lshl_add_u32 v241, v242, 3, v241
    s_waitcnt vmcnt(24) lgkmcnt(2)
    v_mfma_f32_32x32x16_bf16 v[128:143], a[104:107], v[212:215], v[128:143]
    ds_read_b64_tr_b16 v[220:221], v22 offset:23552
    ds_read_b64_tr_b16 v[222:223], v22 offset:24064
    v_lshlrev_b32 v241, v241, 1
    v_mfma_f32_32x32x16_bf16 v[144:159], a[108:111], v[212:215], v[144:159]
    buffer_load_dwordx4 v4, s[12:15], s32 offen offset:3072 lds
    v_lshlrev_b32 v242, 4, v244
    s_waitcnt vmcnt(24) lgkmcnt(2)
    v_mfma_f32_32x32x16_bf16 v[128:143], a[112:115], v[216:219], v[128:143]
    ds_read_b64_tr_b16 v[208:209], v22 offset:0
    ds_read_b64_tr_b16 v[210:211], v22 offset:512
    buffer_load_dword v249, v252, s[52:55], s79 offen offset:0 sc1
    s_movk_i32 s69, 16256
    v_mfma_f32_32x32x16_bf16 v[144:159], a[116:119], v[216:219], v[144:159]
    v_lshlrev_b32 v242, v242, s69
    s_waitcnt vmcnt(24) lgkmcnt(2)
    v_mfma_f32_32x32x16_bf16 v[128:143], a[120:123], v[220:223], v[128:143]
    ds_read_b64_tr_b16 v[212:213], v22 offset:1024
    ds_read_b64_tr_b16 v[214:215], v22 offset:1536
    v_bfe_i32 v56, v241, 0, 1
    v_mfma_f32_32x32x16_bf16 v[144:159], a[124:127], v[220:223], v[144:159]
    v_and_b32 v56, v242, v56
    s_waitcnt vmcnt(23) lgkmcnt(2)
    v_mfma_f32_32x32x16_bf16 v[128:143], a[128:131], v[208:211], v[128:143]
    ds_read_b64_tr_b16 v[216:217], v22 offset:2048
    ds_read_b64_tr_b16 v[218:219], v22 offset:2560
    v_bfe_i32 v57, v241, 1, 1
    v_mfma_f32_32x32x16_bf16 v[144:159], a[132:135], v[208:211], v[144:159]
    v_and_b32 v57, v242, v57
    s_waitcnt vmcnt(22) lgkmcnt(2)
    v_mfma_f32_32x32x16_bf16 v[128:143], a[136:139], v[212:215], v[128:143]
    ds_read_b64_tr_b16 v[220:221], v22 offset:3072
    ds_read_b64_tr_b16 v[222:223], v22 offset:3584
    v_bfe_i32 v58, v241, 2, 1
    v_mfma_f32_32x32x16_bf16 v[144:159], a[140:143], v[212:215], v[144:159]
    v_and_b32 v58, v242, v58
    s_waitcnt vmcnt(17) lgkmcnt(2)
    v_mfma_f32_32x32x16_bf16 v[128:143], a[144:147], v[216:219], v[128:143]
    ds_read_b128 v[208:211], v17 offset:4096
    s_waitcnt vmcnt(12)
    buffer_store_dword v248, v25, s[52:55], s0 offen offset:8 sc1
    v_bfe_i32 v59, v241, 3, 1
    v_mfma_f32_32x32x16_bf16 v[144:159], a[148:151], v[216:219], v[144:159]
    v_and_b32 v59, v242, v59
    s_waitcnt lgkmcnt(1)
    v_mfma_f32_32x32x16_bf16 v[128:143], a[152:155], v[220:223], v[128:143]
    ds_read_b128 v[212:215], v18 offset:4096
    v_bfe_i32 v60, v241, 4, 1
    v_and_b32 v60, v242, v60
    v_mfma_f32_32x32x16_bf16 v[144:159], a[156:159], v[220:223], v[144:159]
    v_bfe_i32 v61, v241, 5, 1
    s_waitcnt lgkmcnt(1)
    v_mfma_f32_32x32x16_bf16 v[128:143], a[160:163], v[208:211], v[128:143]
    ds_read_b128 v[216:219], v19 offset:4096
    v_and_b32 v61, v242, v61
    v_mfma_f32_32x32x16_bf16 v[144:159], a[164:167], v[208:211], v[144:159]
    v_bfe_i32 v62, v241, 6, 1
    s_waitcnt lgkmcnt(1)
    v_mfma_f32_32x32x16_bf16 v[128:143], a[168:171], v[212:215], v[128:143]
    ds_read_b128 v[220:223], v20 offset:4096
    v_and_b32 v62, v242, v62
    v_mfma_f32_32x32x16_bf16 v[144:159], a[172:175], v[212:215], v[144:159]
    v_bfe_i32 v63, v241, 7, 1
    v_and_b32 v63, v242, v63
    s_waitcnt lgkmcnt(1)
    v_mfma_f32_32x32x16_bf16 v[128:143], a[176:179], v[216:219], v[128:143]
    ds_read_b64_tr_b16 v[208:209], v22 offset:8192
    ds_read_b64_tr_b16 v[210:211], v22 offset:8704
    v_mfma_f32_32x32x16_bf16 v[144:159], a[180:183], v[216:219], v[144:159]
    s_waitcnt vmcnt(12) lgkmcnt(2)
    v_mfma_f32_32x32x16_bf16 v[128:143], a[184:187], v[220:223], v[128:143]
    ds_read_b64_tr_b16 v[212:213], v22 offset:9216
    ds_read_b64_tr_b16 v[214:215], v22 offset:9728
    v_mfma_f32_32x32x16_bf16 v[144:159], a[188:191], v[220:223], v[144:159]
    s_waitcnt vmcnt(10) lgkmcnt(2)
    v_mfma_f32_32x32x16_bf16 v[192:207], a[0:3], v[208:211], v[192:207]
    ds_read_b64_tr_b16 v[216:217], v22 offset:10240
    ds_read_b64_tr_b16 v[218:219], v22 offset:10752
    ds_read_b64_tr_b16 v[220:221], v22 offset:11264
    ds_read_b64_tr_b16 v[222:223], v22 offset:11776
    s_waitcnt vmcnt(9) lgkmcnt(4)
    v_mfma_f32_32x32x16_bf16 v[192:207], a[8:11], v[212:215], v[192:207]
    ds_read_b64_tr_b16 v[208:209], v22 offset:12288
    ds_read_b64_tr_b16 v[210:211], v22 offset:12800
    v_cvt_pk_bf16_f32 v96, v128, v129
    v_cvt_pk_bf16_f32 v97, v130, v131
    v_cvt_pk_bf16_f32 v98, v132, v133
    v_cvt_pk_bf16_f32 v99, v134, v135
    s_waitcnt vmcnt(8) lgkmcnt(4)
    v_mfma_f32_32x32x16_bf16 v[192:207], a[16:19], v[216:219], v[192:207]
    ds_read_b64_tr_b16 v[212:213], v22 offset:13312
    ds_read_b64_tr_b16 v[214:215], v22 offset:13824
    buffer_store_dwordx4 v[96:99], v23, s[52:55], s35 offen offset:0 sc1
    v_cvt_pk_bf16_f32 v100, v136, v137
    v_cvt_pk_bf16_f32 v101, v138, v139
    v_cvt_pk_bf16_f32 v102, v140, v141
    v_cvt_pk_bf16_f32 v103, v142, v143
    s_waitcnt vmcnt(8) lgkmcnt(4)
    v_mfma_f32_32x32x16_bf16 v[192:207], a[24:27], v[220:223], v[192:207]
    ds_read_b64_tr_b16 v[216:217], v22 offset:14336
    ds_read_b64_tr_b16 v[218:219], v22 offset:14848
    buffer_store_dwordx4 v[100:103], v23, s[52:55], s35 offen offset:1024 sc1
    v_cvt_pk_bf16_f32 v104, v144, v145
    v_cvt_pk_bf16_f32 v105, v146, v147
    v_cvt_pk_bf16_f32 v106, v148, v149
    v_cvt_pk_bf16_f32 v107, v150, v151
    s_waitcnt vmcnt(8) lgkmcnt(4)
    v_mfma_f32_32x32x16_bf16 v[192:207], a[32:35], v[208:211], v[192:207]
    ds_read_b64_tr_b16 v[220:221], v22 offset:15360
    ds_read_b64_tr_b16 v[222:223], v22 offset:15872
    buffer_store_dwordx4 v[104:107], v24, s[52:55], s35 offen offset:0 sc1
    v_cvt_pk_bf16_f32 v108, v152, v153
    v_cvt_pk_bf16_f32 v109, v154, v155
    v_cvt_pk_bf16_f32 v110, v156, v157
    v_cvt_pk_bf16_f32 v111, v158, v159
    s_waitcnt vmcnt(5) lgkmcnt(4)
    v_mfma_f32_32x32x16_bf16 v[192:207], a[40:43], v[212:215], v[192:207]
    ds_read_b128 v[208:211], v17 offset:16384
    buffer_store_dwordx4 v[108:111], v24, s[52:55], s35 offen offset:1024 sc1
    s_waitcnt vmcnt(5)
    v_cmp_ne_u32 vcc, 0, v249
    s_nop 0
    s_cbranch_vccnz L_f0_slow
L_f0_ok:
    s_waitcnt lgkmcnt(3)
    v_mfma_f32_32x32x16_bf16 v[192:207], a[48:51], v[216:219], v[192:207]
    ds_read_b128 v[212:215], v18 offset:16384
    buffer_load_dwordx4 v[64:67], v23, s[52:55], s78 offen offset:0 sc1
    buffer_load_dwordx4 v[68:71], v23, s[52:55], s78 offen offset:1024 sc1
    buffer_load_dwordx4 v[72:75], v23, s[52:55], s83 offen offset:0 sc1
    buffer_load_dwordx4 v[76:79], v23, s[52:55], s83 offen offset:1024 sc1
    s_waitcnt lgkmcnt(2)
    v_mfma_f32_32x32x16_bf16 v[192:207], a[56:59], v[220:223], v[192:207]
    ds_read_b128 v[216:219], v19 offset:16384
    s_waitcnt lgkmcnt(2)
    v_mfma_f32_32x32x16_bf16 v[192:207], a[64:67], v[208:211], v[192:207]
    ds_read_b128 v[220:223], v20 offset:16384
    s_waitcnt lgkmcnt(1)
    v_mfma_f32_32x32x16_bf16 v[192:207], a[72:75], v[212:215], v[192:207]
    v_mfma_f32_32x32x16_bf16 v[192:207], a[80:83], v[216:219], v[192:207]
    s_waitcnt lgkmcnt(0)
    v_mfma_f32_32x32x16_bf16 v[192:207], a[88:91], v[220:223], v[192:207]
    s_barrier
    ds_read_b64_tr_b16 v[208:209], v21 offset:8192
    ds_read_b64_tr_b16 v[210:211], v21 offset:8704
    ds_read_b64_tr_b16 v[212:213], v21 offset:9216
    ds_read_b64_tr_b16 v[214:215], v21 offset:9728
    ds_read_b64_tr_b16 v[216:217], v21 offset:10240
    ds_read_b64_tr_b16 v[218:219], v21 offset:10752
    s_waitcnt lgkmcnt(4)
    v_mfma_f32_32x32x16_bf16 v[192:207], a[96:99], v[208:211], v[192:207]
    ds_read_b64_tr_b16 v[220:221], v21 offset:11264
    ds_read_b64_tr_b16 v[222:223], v21 offset:11776
    s_waitcnt lgkmcnt(4)
    v_mfma_f32_32x32x16_bf16 v[192:207], a[104:107], v[212:215], v[192:207]
    ds_read_b64_tr_b16 v[208:209], v21 offset:12288
    ds_read_b64_tr_b16 v[210:211], v21 offset:12800
    s_waitcnt lgkmcnt(4)
    v_mfma_f32_32x32x16_bf16 v[192:207], a[112:115], v[216:219], v[192:207]
    ds_read_b64_tr_b16 v[212:213], v21 offset:13312
    ds_read_b64_tr_b16 v[214:215], v21 offset:13824
    s_waitcnt lgkmcnt(4)
    v_mfma_f32_32x32x16_bf16 v[192:207], a[120:123], v[220:223], v[192:207]
    ds_read_b64_tr_b16 v[216:217], v21 offset:14336
    ds_read_b64_tr_b16 v[218:219], v21 offset:14848
    s_waitcnt lgkmcnt(4)
    v_mfma_f32_32x32x16_bf16 v[192:207], a[128:131], v[208:211], v[192:207]
    ds_read_b64_tr_b16 v[220:221], v21 offset:15360
    ds_read_b64_tr_b16 v[222:223], v21 offset:15872
    s_waitcnt lgkmcnt(4)
    v_mfma_f32_32x32x16_bf16 v[192:207], a[136:139], v[212:215], v[192:207]
    ds_read_b128 v[208:211], v13 offset:16384
    s_waitcnt lgkmcnt(3)
    v_mfma_f32_32x32x16_bf16 v[192:207], a[144:147], v[216:219], v[192:207]
    ds_read_b128 v[212:215], v14 offset:16384
    s_waitcnt lgkmcnt(2)
    v_mfma_f32_32x32x16_bf16 v[192:207], a[152:155], v[220:223], v[192:207]
    ds_read_b128 v[216:219], v15 offset:16384
    s_waitcnt lgkmcnt(2)
    v_mfma_f32_32x32x16_bf16 v[192:207], a[160:163], v[208:211], v[192:207]
    ds_read_b128 v[220:223], v16 offset:16384
    buffer_load_dword v250, v252, s[52:55], s79 offen offset:8 sc1
    s_waitcnt lgkmcnt(1)
    v_mfma_f32_32x32x16_bf16 v[192:207], a[168:171], v[212:215], v[192:207]
    v_mfma_f32_32x32x16_bf16 v[192:207], a[176:179], v[216:219], v[192:207]
    s_waitcnt lgkmcnt(0) vmcnt(5)
    v_mfma_f32_32x32x16_bf16 v[192:207], a[184:187], v[220:223], v[192:207]
    buffer_store_dword v248, v25, s[52:55], s1 offen offset:144 sc1
    s_waitcnt vmcnt(1)
    v_cmp_ne_u32 vcc, 0, v250
    s_nop 0
    s_cbranch_vccnz L_f1_slow
L_f1_ok:
    buffer_load_dwordx4 v[80:83], v23, s[52:55], s84 offen offset:0 sc1
    buffer_load_dwordx4 v[84:87], v23, s[52:55], s84 offen offset:1024 sc1
    buffer_load_dwordx4 v[88:91], v23, s[52:55], s85 offen offset:0 sc1
    buffer_load_dwordx4 v[92:95], v23, s[52:55], s85 offen offset:1024 sc1
    buffer_load_dword v251, v252, s[52:55], s79 offen offset:144 sc1
    v_mfma_f32_32x32x16_bf16 v[192:207], v[56:59], v[64:67], v[192:207]
    v_mfma_f32_32x32x16_bf16 v[192:207], v[60:63], v[68:71], v[192:207]
    v_mfma_f32_32x32x16_bf16 v[192:207], v[56:59], v[72:75], v[192:207]
    v_mfma_f32_32x32x16_bf16 v[192:207], v[60:63], v[76:79], v[192:207]
    s_waitcnt vmcnt(3)
    v_mfma_f32_32x32x16_bf16 v[192:207], v[56:59], v[80:83], v[192:207]
    v_mfma_f32_32x32x16_bf16 v[192:207], v[60:63], v[84:87], v[192:207]
    s_waitcnt vmcnt(1)
    v_mfma_f32_32x32x16_bf16 v[192:207], v[56:59], v[88:91], v[192:207]
    v_mfma_f32_32x32x16_bf16 v[192:207], v[60:63], v[92:95], v[192:207]
    s_waitcnt vmcnt(0)
    v_cmp_ne_u32 vcc, 0, v251
    s_nop 0
    s_cbranch_vccnz L_f2_slow
L_f2_ok:
    buffer_load_dwordx4 v[112:115], v23, s[52:55], s86 offen offset:0 sc1
    buffer_load_dwordx4 v[116:119], v23, s[52:55], s86 offen offset:1024 sc1
    buffer_load_dwordx4 v[120:123], v23, s[52:55], s87 offen offset:0 sc1
    buffer_load_dwordx4 v[124:127], v23, s[52:55], s87 offen offset:1024 sc1
    s_waitcnt vmcnt(2)
    v_mfma_f32_32x32x16_bf16 v[192:207], v[56:59], v[112:115], v[192:207]
    v_mfma_f32_32x32x16_bf16 v[192:207], v[60:63], v[116:119], v[192:207]
    s_waitcnt vmcnt(0)
    v_mfma_f32_32x32x16_bf16 v[192:207], v[56:59], v[120:123], v[192:207]
    v_mfma_f32_32x32x16_bf16 v[192:207], v[60:63], v[124:127], v[192:207]
    s_nop 11
    buffer_store_dword v192, v28, s[48:51], s80 offen offset:0 sc1
    buffer_store_dword v193, v28, s[48:51], s80 offen offset:1792 sc1
    buffer_store_dword v194, v28, s[48:51], s80 offen offset:3584 sc1
    s_add_u32 s80, s80, 5376
    buffer_store_dword v195, v28, s[48:51], s80 offen offset:0 sc1
    buffer_store_dword v196, v28, s[48:51], s80 offen offset:1792 sc1
    buffer_store_dword v197, v28, s[48:51], s80 offen offset:3584 sc1
    s_add_u32 s80, s80, 5376
    buffer_store_dword v198, v28, s[48:51], s80 offen offset:0 sc1
    buffer_store_dword v199, v28, s[48:51], s80 offen offset:1792 sc1
    buffer_store_dword v200, v28, s[48:51], s80 offen offset:3584 sc1
    s_add_u32 s80, s80, 5376
    buffer_store_dword v201, v28, s[48:51], s80 offen offset:0 sc1
    buffer_store_dword v202, v28, s[48:51], s80 offen offset:1792 sc1
    buffer_store_dword v203, v28, s[48:51], s80 offen offset:3584 sc1
    s_add_u32 s80, s80, 5376
    buffer_store_dword v204, v28, s[48:51], s80 offen offset:0 sc1
    buffer_store_dword v205, v28, s[48:51], s80 offen offset:1792 sc1
    buffer_store_dword v206, v28, s[48:51], s80 offen offset:3584 sc1
    s_add_u32 s80, s80, 5376
    buffer_store_dword v207, v28, s[48:51], s80 offen offset:0 sc1
L_end:
    s_endpgm
L_dbg_slow:
    s_sub_u32 s71, s71, 1
    s_cmp_lt_i32 s71, 0
    s_cbranch_scc1 L_dbg_ok
    buffer_load_dword v253, v255, s[56:59], 0 offen sc1
    s_waitcnt vmcnt(0)
    v_cmp_ne_u32 vcc, 1, v253
    s_nop 0
    s_cbranch_vccnz L_dbg_slow
    s_branch L_dbg_ok
L_st_slow:
    s_sub_u32 s71, s71, 1
    s_cmp_lt_i32 s71, 0
    s_cbranch_scc1 L_st_ok
    buffer_load_dwordx2 v[64:65], v26, s[36:39], 0 offen offset:0 sc1
    buffer_load_dwordx2 v[66:67], v26, s[36:39], 0 offen offset:128 sc1
    buffer_load_dwordx2 v[68:69], v26, s[36:39], 0 offen offset:256 sc1
    buffer_load_dwordx2 v[70:71], v26, s[36:39], 0 offen offset:384 sc1
    buffer_load_dwordx2 v[72:73], v26, s[36:39], 0 offen offset:512 sc1
    buffer_load_dwordx2 v[74:75], v26, s[36:39], 0 offen offset:640 sc1
    buffer_load_dwordx2 v[76:77], v26, s[36:39], 0 offen offset:768 sc1
    buffer_load_dwordx2 v[78:79], v26, s[36:39], 0 offen offset:896 sc1
    s_waitcnt vmcnt(0)
    v_max3_u32 v224, v64, v65, v66
    v_max3_u32 v225, v67, v68, v69
    v_max3_u32 v224, v224, v70, v71
    v_max3_u32 v225, v225, v72, v73
    v_max3_u32 v224, v224, v74, v75
    v_max3_u32 v225, v225, v76, v77
    v_max3_u32 v224, v224, v78, v79
    v_max_u32 v224, v224, v225
    v_cmp_eq_u32 vcc, -1, v224
    s_nop 0
    s_cbranch_vccnz L_st_slow
    s_branch L_st_ok
L_f0_slow:
    s_sub_u32 s71, s71, 1
    s_cmp_lt_i32 s71, 0
    s_cbranch_scc1 L_f0_ok
    buffer_load_dword v249, v252, s[52:55], s79 offen offset:0 sc1
    s_waitcnt vmcnt(0)
    v_cmp_ne_u32 vcc, 0, v249
    s_nop 0
    s_cbranch_vccnz L_f0_slow
    s_branch L_f0_ok
L_f1_slow:
    s_sub_u32 s71, s71, 1
    s_cmp_lt_i32 s71, 0
    s_cbranch_scc1 L_f1_ok
    buffer_load_dword v250, v252, s[52:55], s79 offen offset:8 sc1
    s_waitcnt vmcnt(0)
    v_cmp_ne_u32 vcc, 0, v250
    s_nop 0
    s_cbranch_vccnz L_f1_slow
    s_branch L_f1_ok
L_f2_slow:
    s_sub_u32 s71, s71, 1
    s_cmp_lt_i32 s71, 0
    s_cbranch_scc1 L_f2_ok
    buffer_load_dword v251, v252, s[52:55], s79 offen offset:144 sc1
    s_waitcnt vmcnt(11)
    v_cmp_ne_u32 vcc, 0, v251
    s_nop 0
    s_cbranch_vccnz L_f2_slow
    s_branch L_f2_ok
L_helper:
    s_getpc_b64 s[78:79]
L_pc:
    s_sub_u32 s78, s78, L_pc-gated_mix__ssm_conv_s5__dense_activation_mish__prompt_kernel
    s_subb_u32 s79, s79, 0
    s_lshl_b32 s70, s70, 13
    v_lshl_add_u32 v8, v0, 5, s70
    v_min_u32 v8, L_helper-gated_mix__ssm_conv_s5__dense_activation_mish__prompt_kernel, v8
    global_load_dword v9, v8, s[78:79]
    s_mov_b32 s58, 0x100
    s_mov_b32 s59, 0x20000
    s_mov_b32 s54, 0x38000
    s_mov_b32 s55, 0x20000
    s_mov_b32 s30, 0x62000
    s_mov_b32 s31, 0x20000
    s_mul_i32 s68, s2, 8192
    v_lshl_add_u32 v1, v0, 4, s68
    v_mov_b32 v4, -1
    v_mov_b32 v5, -1
    v_mov_b32 v6, -1
    v_mov_b32 v7, -1
    v_mov_b32 v2, 1
    s_lshl_b32 s69, s2, 2
    v_lshl_add_u32 v3, v0, 8, s69
    s_lshl_b32 s69, s2, 8
    v_add_u32 v10, s69, v0
    v_lshlrev_b32 v11, 7, v10
    v_sub_u32 v12, 1048448, v11
    v_and_b32 v13, 1, v10
    v_sub_u32 v14, v10, v13
    v_lshl_add_u32 v13, v14, 1, v13
    v_lshlrev_b32 v13, 7, v13
    v_sub_u32 v14, 2097024, v13
    s_waitcnt lgkmcnt(0)
    buffer_store_dwordx4 v[4:7], v1, s[52:55], 0 offen sc1
    v_add_u32 v1, 4096, v1
    buffer_store_dwordx4 v[4:7], v1, s[52:55], 0 offen sc1
    v_add_u32 v1, 4096, v1
    s_mov_b64 s[56:57], s[50:51]
    s_mov_b64 s[12:13], s[14:15]
    s_mov_b32 s14, 0x62000
    s_mov_b32 s15, 0x20000
    s_mov_b32 s18, 0x62000
    s_mov_b32 s19, 0x20000
    s_mov_b32 s42, 0x188000
    s_mov_b32 s43, 0x20000
    s_mov_b32 s46, 0x188000
    s_mov_b32 s47, 0x20000
    s_cmp_ge_u32 s2, 28
    s_cbranch_scc1 L_pf
    s_waitcnt vmcnt(0)
    s_barrier
    buffer_store_dword v2, v3, s[56:59], 0 offen sc1
L_pf:
    s_and_b32 s69, s2, 7
    s_lshl_b32 s69, s69, 2
    s_lshr_b32 s63, 0x55202031, s69
    s_lshr_b32 s70, 0x64316464, s69
    s_lshr_b32 s62, s2, 3
    s_bitcmp1_b32 s62, 0
    s_cselect_b32 s63, s70, s63
    s_and_b32 s63, s63, 7
    s_lshr_b32 s62, s62, 1
    s_lshl_b32 s62, s62, 8
    v_add_u32 v10, s62, v0
    v_lshrrev_b32 v11, 1, v10
    v_and_b32 v12, 1, v10
    v_mul_u32_u24 v11, 3584, v11
    v_lshl_add_u32 v11, v12, 7, v11
    s_lshl_b32 s69, s63, 9
    v_add_u32 v11, s69, v11
    v_add_u32 v12, 917504, v11
    s_mul_i32 s68, s63, 229376
    s_add_u32 s46, s68, 229376
    v_lshl_add_u32 v13, v10, 7, s68
    v_mul_u32_u24 v14, 896, v10
    s_lshl_b32 s69, s63, 7
    v_add_u32 v14, s69, v14
    buffer_load_dword v9, v11, s[40:43], 0 offen
    buffer_load_dword v9, v12, s[40:43], 0 offen
    buffer_load_dword v9, v11, s[40:43], 0 offen offset:256
    buffer_load_dword v9, v12, s[40:43], 0 offen offset:256
    buffer_load_dword v9, v13, s[44:47], 0 offen
    v_add_u32 v13, 65536, v13
    buffer_load_dword v9, v13, s[44:47], 0 offen
    v_add_u32 v13, 65536, v13
    buffer_load_dword v9, v14, s[12:15], 0 offen
    buffer_load_dword v9, v13, s[44:47], 0 offen
    v_add_u32 v13, 65536, v13
    buffer_load_dword v9, v13, s[44:47], 0 offen
    v_add_u32 v13, 65536, v13
    buffer_load_dword v9, v14, s[16:19], 0 offen
    s_waitcnt vmcnt(0)
    s_endpgm
.section .rodata,"a"
.p2align 6
.amdhsa_kernel gated_mix__ssm_conv_s5__dense_activation_mish__prompt_kernel
  .amdhsa_next_free_vgpr 512
  .amdhsa_next_free_sgpr 102
  .amdhsa_accum_offset 256
  .amdhsa_group_segment_fixed_size 0
  .amdhsa_kernarg_size 136
  .amdhsa_user_sgpr_count 2
  .amdhsa_user_sgpr_kernarg_segment_ptr 1
  .amdhsa_system_sgpr_workgroup_id_x 1
.end_amdhsa_kernel
```
